```python
import torch

def _softmax(x, axis=-1):
    return torch.softmax(x, dim=axis)
def _gelu(x):
    return torch.nn.functional.gelu(x, approximate="tanh")
def _silu(x):
    return torch.nn.functional.silu(x)
def _sigmoid(x):
    return torch.sigmoid(x)
def _layernorm(x, axis=-1, eps=1e-5):
    m = x.mean(dim=axis, keepdim=True)
    v = x.var(dim=axis, keepdim=True, unbiased=False)
    return (x - m) / torch.sqrt(v + eps)
def _scatter_add(tgt, idx, src, axis=0):
    return tgt.clone().index_add_(axis, idx, src)
def _segment_sum(src, seg, n):
    out = torch.zeros((n,) + src.shape[1:], dtype=src.dtype)
    return out.index_add_(0, seg, src)
def _pad(x, pw):
    flat = tuple(v for pair in reversed(pw) for v in pair)
    return torch.nn.functional.pad(x, flat)

kernel_name = 'interleave_layers__sliding_block_cached__glu_gated_swiglu__decode'

def setup_inputs():

    _w = (lambda a: (lambda t: t.to(torch.bfloat16) if t.is_floating_point() else t)(torch.as_tensor(a)))
    def _A_setup():
        B, Sq, D = 1, 1, 512
        Hq, Hkv, Sk, Dh = 32, 8, 65536, 128
        assert Hq % Hkv == 0, (Hq, Hkv)
        return {
            "x": _w((lambda *s: torch.randn(*s, dtype=torch.bfloat16) * 0.05)(B, Sq, D)),
            "k_cache": _w((lambda *s: torch.randn(*s, dtype=torch.bfloat16) * 0.8)(B, Hkv, Sk, Dh)),
            "v_cache": _w((lambda *s: torch.randn(*s, dtype=torch.bfloat16) * 0.8)(B, Hkv, Sk, Dh)),
            "wq": _w((lambda *s: torch.randn(*s, dtype=torch.bfloat16) * 0.8)(D, Hq * Dh) * (D ** -0.5)),
            "wo": _w((lambda *s: torch.randn(*s, dtype=torch.bfloat16) * 0.8)(Hq * Dh, D) * ((Hq * Dh) ** -0.5)),
        }
    _A_in = _A_setup()

    def _B_setup():
        B, S, D, F = 1, 1, 512, 1792
        return {
            "x": _w((lambda *s: torch.randn(*s, dtype=torch.bfloat16) * 0.05)(B, S, D)),
            "w1": _w((lambda *s: torch.randn(*s, dtype=torch.bfloat16) * 0.2)(D, F) * (2.0 / D) ** 0.5),
            "w3": _w((lambda *s: torch.randn(*s, dtype=torch.bfloat16) * 0.2)(D, F) * (2.0 / D) ** 0.5),
            "w2": _w((lambda *s: torch.randn(*s, dtype=torch.bfloat16) * 0.2)(F, D) * (2.0 / F) ** 0.5),
        }
    _B_in = _B_setup()

    return {
        "A_x": _A_in["x"],
        "A_k_cache": _A_in["k_cache"],
        "A_v_cache": _A_in["v_cache"],
        "A_wq": _A_in["wq"],
        "A_wo": _A_in["wo"],
        "B_x": _B_in["x"],
        "B_w1": _B_in["w1"],
        "B_w3": _B_in["w3"],
        "B_w2": _B_in["w2"],
    }

def reference(A_x, A_k_cache, A_v_cache, A_wq, A_wo, B_x, B_w1, B_w3, B_w2):
    def _A_ref(x, k_cache, v_cache, wq, wo):
        B, Sq, D = x.shape
        Hq, Dh = 32, 128
        Hkv, Sk = k_cache.shape[1], k_cache.shape[2]
        W = min(4096, max(256, Sk // 4))
        rep = Hq // Hkv
        q = (lambda x, *d: x.permute(*d))((x @ wq).reshape(B, Sq, Hq, Dh), 0, 2, 1, 3)
        k = (lambda x, n, axis: torch.repeat_interleave(x, n, dim=axis))(k_cache[:, :, Sk - W:, :], rep, axis=1)
        v = (lambda x, n, axis: torch.repeat_interleave(x, n, dim=axis))(v_cache[:, :, Sk - W:, :], rep, axis=1)
        scores = torch.einsum("bhqd,bhkd->bhqk", q, k) * (Dh ** -0.5)
        p = _softmax(scores, axis=-1)
        o = torch.einsum("bhqk,bhkd->bhqd", p, v)
        return (lambda x, *d: x.permute(*d))(o, 0, 2, 1, 3).reshape(B, Sq, Hq * Dh) @ wo

    def _B_ref(x, w1, w3, w2):
        gate = torch.einsum("bsd,df->bsf", x, w1)
        up = torch.einsum("bsd,df->bsf", x, w3)
        h = _silu(gate) * up
        out = torch.einsum("bsf,fd->bsd", h, w2)
        return out

    x = A_x
    x = x + _A_ref(_layernorm(x, axis=-1), A_k_cache, A_v_cache, A_wq, A_wo)
    x = x + _B_ref(_layernorm(x, axis=-1), B_w1, B_w3, B_w2)
    x = x + _A_ref(_layernorm(x, axis=-1), A_k_cache, A_v_cache, A_wq, A_wo)
    x = x + _B_ref(_layernorm(x, axis=-1), B_w1, B_w3, B_w2)
    return x
```

```asm
; @launch grid=(256,1,1) block=(256,1,1) lds=127232
.amdgcn_target "amdgcn-amd-amdhsa--gfx950"
.text
.globl interleave_layers__sliding_block_cached__glu_gated_swiglu__decode_kernel
.p2align 12
.p2align 8
.type interleave_layers__sliding_block_cached__glu_gated_swiglu__decode_kernel,@function
interleave_layers__sliding_block_cached__glu_gated_swiglu__decode_kernel:
    s_load_dwordx16 s[20:35], s[0:1], 8
    s_load_dwordx16 s[4:19], s[0:1], 0
    s_load_dwordx2 s[44:45], s[0:1], 88
    s_load_dwordx2 s[36:37], s[0:1], 64
    s_load_dwordx2 s[40:41], s[0:1], 72
    s_getpc_b64 s[80:81]
    s_bfe_u32 s66, s2, 0x20003
    s_lshl_b32 s66, s66, 12
    s_and_b32 s80, s80, 0xfffff000
    v_lshl_add_u32 v236, v0, 4, s66
    s_cmp_ge_u32 s2, 32
    s_cbranch_scc1 L_nocode
    global_load_dwordx4 v[184:187], v236, s[80:81]
L_nocode:
    s_cmp_ge_u32 s2, 256
    s_cbranch_scc1 L_end
    s_lshr_b32 s49, s2, 3
    v_lshrrev_b32 v237, 6, v0
    s_and_b32 s48, s2, 7
    v_readfirstlane_b32 s52, v237
    s_lshr_b32 s50, s2, 6
    s_and_b32 s51, s49, 7
    s_lshl_b32 s53, s48, 2
    s_add_u32 s53, s53, s50
    v_and_b32 v2, 15, v0
    v_bfe_u32 v3, v0, 4, 2
    v_and_b32 v4, 63, v0
    v_lshlrev_b32 v1, 4, v4
    s_mov_b32 s46, 4194304
    s_mov_b32 s47, 0x20000
    s_mov_b32 s38, 1835008
    s_mov_b32 s39, 0x20000
    s_mov_b32 s42, 1024
    s_mov_b32 s43, 0x20000
    v_and_b32 v238, 3, v0
    v_lshl_add_u32 v238, v238, 2, v3
    v_lshl_add_u32 v238, v237, 4, v238
    v_lshlrev_b32 v14, 1, v238
    s_lshl_b32 s67, s51, 7
    v_lshrrev_b32 v239, 4, v0
    v_lshrrev_b32 v240, 7, v0
    v_lshl_add_u32 v240, v240, 2, v3
    v_lshlrev_b32 v240, 1, v240
    v_xor_b32 v240, v240, v2
    v_lshlrev_b32 v240, 4, v240
    v_lshl_add_u32 v240, v239, 13, v240
    s_lshl_b32 s65, s51, 19
    s_lshl_b32 s66, s53, 8
    s_add_u32 s65, s65, s66
    s_lshl_b32 s64, s52, 10
    s_mov_b32 m0, s64
    s_mul_i32 s62, s48, 16777216
    s_lshl_b32 s66, s49, 12
    s_add_u32 s62, s62, s66
    s_add_u32 s62, s62, 15728640
    s_mul_i32 s63, s48, 90112
    s_add_u32 s63, s63, 524288
    s_lshl_b32 s76, s53, 17
    s_lshl_b32 s66, s51, 7
    s_add_u32 s76, s76, s66
    v_xor_b32 v176, v2, v239
    v_lshl_add_u32 v176, v239, 4, v176
    v_lshlrev_b32 v176, 4, v176
    s_mov_b32 s73, s65
    s_mov_b32 s74, s67
    s_waitcnt lgkmcnt(0)
    s_mov_b32 s26, 4194304
    s_mov_b32 s27, 0x20000
    s_mov_b32 s6, 1024
    s_mov_b32 s7, 0x20000
    buffer_load_dwordx4 v[188:191], v1, s[4:7], 0 offen
    buffer_load_ushort v33, v14, s[4:7], s74 offen
    buffer_load_dwordx4 v240, s[24:27], s65 offen offset:0 nt lds
    s_load_dword s28, s[20:21], s62
    s_load_dword s54, s[44:45], 0
    s_add_u32 m0, s64, 4096
    s_add_u32 s65, s73, 131072
    buffer_load_dwordx4 v240, s[24:27], s65 offen offset:0 nt lds
    s_add_u32 m0, s64, 8192
    s_add_u32 s65, s73, 262144
    buffer_load_dwordx4 v240, s[24:27], s65 offen offset:0 nt lds
    s_add_u32 m0, s64, 12288
    s_add_u32 s65, s73, 393216
    buffer_load_dwordx4 v240, s[24:27], s65 offen offset:0 nt lds
    s_lshl_b32 s66, s52, 5
    s_add_u32 s66, s66, s49
    s_lshl_b32 s66, s66, 8
    s_add_u32 s66, s66, s63
    v_lshlrev_b32 v241, 2, v4
    v_mov_b32 v244, -1
    buffer_load_dword v192, v241, s[44:47], s66 offen nt
    buffer_store_dword v244, v241, s[44:47], s66 offen
    s_lshl_b32 s66, s48, 5
    s_add_u32 s66, s66, s49
    s_lshl_b32 s66, s66, 1
    s_add_u32 s66, s66, s52
    s_lshl_b32 s66, s66, 8
    s_add_u32 s66, s66, 65536
    s_lshr_b32 s67, s49, 2
    s_lshl_b32 s67, s67, 7
    s_add_u32 s67, s67, s64
    s_add_u32 s67, s67, s63
    s_add_u32 s67, s67, 30720
    s_cmp_lt_u32 s52, 2
    s_cselect_b32 s66, s66, s67
    buffer_load_dword v193, v241, s[44:47], s66 offen nt
    s_barrier
    s_mov_b32 s22, 134217728
    s_mov_b32 s23, 0x20000
    s_add_u32 m0, s64, 16384
    s_xor_b32 s65, s62, 0
    buffer_load_dwordx4 v176, s[20:23], s65 offen offset:0 nt lds
    s_add_u32 m0, s64, 20480
    s_xor_b32 s65, s62, 544768
    buffer_load_dwordx4 v176, s[20:23], s65 offen offset:0 nt lds
    s_add_u32 m0, s64, 24576
    s_xor_b32 s65, s62, 270336
    buffer_load_dwordx4 v176, s[20:23], s65 offen offset:0 nt lds
    s_add_u32 m0, s64, 28672
    s_xor_b32 s65, s62, 815104
    buffer_load_dwordx4 v176, s[20:23], s65 offen offset:0 nt lds
    s_mov_b32 s10, 134217728
    s_mov_b32 s11, 0x20000
    s_mov_b32 s14, 4194304
    s_mov_b32 s15, 0x20000
    s_mov_b32 s18, 1835008
    s_mov_b32 s19, 0x20000
    s_mov_b32 s34, 1835008
    s_mov_b32 s35, 0x20000
    s_mov_b32 s69, 0xffff0000
    s_mov_b32 s70, 0xfffffffe
    s_mov_b32 s71, 0xffffff00
    s_mov_b32 s61, 400000
    s_getreg_b32 s68, hwreg(HW_REG_XCC_ID, 0, 4)
    v_and_b32 v238, 3, v0
    v_bfe_u32 v239, v0, 2, 2
    v_mov_b32 v243, 1073741824
    v_mov_b32 v60, 0x3f803f80
    v_mov_b32 v61, v60
    v_mov_b32 v62, v60
    v_mov_b32 v63, v60
    v_and_b32 v240, 31, v0
    v_lshlrev_b32 v240, 2, v240
    v_add_u32 v240, 123008, v240
    ds_write_b32 v240, v60
    v_lshlrev_b32 v240, 2, v238
    v_add_u32 v240, 123360, v240
    v_mov_b32 v241, 0
    ds_write_b32 v240, v241
    s_lshl_b32 s66, s51, 7
    v_add_u32 v13, s66, v14
    v_cmp_eq_u32 vcc, 0, v239
    v_add_u32 v14, 122880, v14
    s_nop 0
    v_cndmask_b32 v13, v243, v13, vcc
    v_lshlrev_b32 v240, 4, v3
    v_add_u32 v17, 123136, v240
    v_and_b32 v241, 1, v0
    v_lshl_add_u32 v15, v241, 7, v240
    v_add_u32 v15, 122880, v15
    v_lshl_add_u32 v245, v3, 3, v239
    v_and_b32 v244, 1, v3
    v_lshl_add_u32 v244, v244, 2, v239
    v_lshlrev_b32 v246, 1, v237
    v_xor_b32 v244, v244, v246
    v_lshl_add_u32 v244, v244, 2, v238
    v_lshl_add_u32 v244, v245, 5, v244
    v_lshlrev_b32 v234, 3, v244
    v_xor_b32 v229, 32, v234
    v_cmp_gt_u32 vcc, 32, v4
    s_lshl_b32 s66, s50, 4
    s_add_u32 s66, s66, s51
    s_lshl_b32 s66, s66, 8
    s_add_u32 s66, s66, 73728
    v_lshl_add_u32 v244, v237, 5, v4
    v_lshl_add_u32 v245, v244, 1, s66
    s_lshl_b32 s66, s53, 3
    s_add_u32 s66, s66, s51
    s_lshl_b32 s66, s66, 9
    s_add_u32 s66, s66, 65536
    v_cndmask_b32 v5, v243, v245, vcc
    v_lshl_add_u32 v246, v244, 2, s66
    v_cndmask_b32 v233, v243, v246, vcc
    v_and_b32 v39, 16, v0
    s_lshl_b32 s66, s48, 2
    s_add_u32 s66, s66, s52
    s_lshl_b32 s66, s66, 12
    s_add_u32 s66, s66, 65536
    v_lshl_add_u32 v244, v3, 5, v2
    v_lshl_add_u32 v231, v244, 4, s66
    s_lshl_b32 s73, s52, 12
    s_add_u32 s73, s73, s63
    s_add_u32 s73, s73, 73728
    s_lshl_b32 s75, s50, 2
    s_add_u32 s75, s75, s52
    s_lshl_b32 s75, s75, 11
    s_add_u32 s75, s75, s63
    s_cmp_gt_u32 s48, 0
    s_cselect_b32 s66, 4, 0
    s_sub_u32 s66, s53, s66
    s_mul_i32 s77, s51, 229376
    s_lshl_b32 s67, s66, 7
    s_add_u32 s77, s77, s67
    s_cmp_eq_u32 s48, 0
    s_cselect_b32 s77, 1073741824, s77
    s_add_u32 s78, s77, 114688
    s_lshl_b32 s79, s66, 16
    s_lshl_b32 s67, s51, 7
    s_add_u32 s79, s79, s67
    s_cmp_eq_u32 s48, 0
    s_cselect_b32 s79, 1073741824, s79
    v_lshrrev_b32 v244, 4, v0
    v_and_b32 v245, 7, v244
    v_lshlrev_b32 v245, 1, v245
    v_xor_b32 v245, v245, v2
    v_lshl_add_u32 v245, v244, 4, v245
    v_lshlrev_b32 v230, 4, v245
    v_and_b32 v244, 1, v3
    v_and_b32 v245, 1, v237
    v_lshl_add_u32 v244, v245, 1, v244
    v_lshlrev_b32 v244, 1, v244
    v_and_b32 v245, 7, v0
    v_xor_b32 v244, v244, v245
    v_lshlrev_b32 v244, 4, v244
    v_lshrrev_b32 v245, 3, v0
    v_lshl_add_u32 v37, v245, 10, v244
    v_mul_u32_u24 v245, 3584, v245
    v_add_u32 v38, v245, v244
    s_waitcnt lgkmcnt(0)
    s_add_u32 s54, s54, 0x674f1b34
    s_and_b32 s54, s54, -4
    v_mov_b32 v43, s54
    v_mov_b32 v45, s54
    v_mov_b32 v40, 0xfffe
    s_lshr_b32 s66, s54, 16
    s_bfe_u32 s55, s54, 524288
    s_bfe_u32 s56, s54, 524296
    s_bfe_u32 s57, s54, 524304
    s_bfe_u32 s58, s54, 524312
    s_and_b32 s59, s54, 0xbff0
    s_or_b32 s59, s59, s68
    s_and_b32 s60, s66, 0xbff0
    s_or_b32 s60, s60, s68
    v_lshlrev_b32 v244, 3, v238
    v_lshrrev_b32 v32, v244, s54
    v_and_b32 v32, 0xff, v32
    v_and_b32 v244, 1, v0
    v_cmp_eq_u32 vcc, 1, v244
    v_mov_b32 v244, s59
    v_mov_b32 v245, s60
    v_cndmask_b32 v232, v244, v245, vcc
    s_waitcnt vmcnt(11)
    v_lshlrev_b32 v33, 16, v33
    v_lshlrev_b32 v244, 16, v188
    v_and_b32 v245, s69, v188
    v_lshlrev_b32 v246, 16, v189
    v_and_b32 v247, s69, v189
    v_lshlrev_b32 v248, 16, v190
    v_and_b32 v249, s69, v190
    v_lshlrev_b32 v250, 16, v191
    v_and_b32 v251, s69, v191
    v_add_f32 v236, v244, v245
    v_mul_f32 v237, v244, v244
    v_fmac_f32 v237, v245, v245
    v_add_f32 v236, v236, v246
    v_fmac_f32 v237, v246, v246
    v_add_f32 v236, v236, v247
    v_fmac_f32 v237, v247, v247
    v_add_f32 v236, v236, v248
    v_fmac_f32 v237, v248, v248
    v_add_f32 v236, v236, v249
    v_fmac_f32 v237, v249, v249
    v_add_f32 v236, v236, v250
    v_fmac_f32 v237, v250, v250
    v_add_f32 v236, v236, v251
    v_fmac_f32 v237, v251, v251
    s_nop 1
    v_permlane32_swap_b32 v236, v237
    v_add_f32 v236, v236, v237
    v_mov_b32 v237, v236
    s_nop 1
    v_permlane16_swap_b32 v236, v237
    v_add_f32 v236, v236, v237
    s_nop 1
    v_add_f32_dpp v236, v236, v236 row_ror:8
    s_nop 1
    v_add_f32_dpp v236, v236, v236 row_ror:4
    s_nop 1
    v_add_f32_dpp v236, v236, v236 quad_perm:[2,3,0,1]
    s_nop 1
    v_add_f32_dpp v236, v236, v236 quad_perm:[1,0,3,2]
    v_mul_f32 v236, 0x3b000000, v236
    v_mov_b32 v237, v236
    s_nop 1
    v_permlane32_swap_b32 v236, v237
    v_cvt_pk_bf16_f32 v34, v236, v236
    v_and_b32 v34, s69, v34
    v_fma_f32 v237, -v236, v236, v237
    v_max_f32 v237, 0, v237
    v_cvt_pk_bf16_f32 v237, v237, v237
    v_and_b32 v237, s69, v237
    v_add_f32 v237, 0x3727c5ac, v237
    v_cvt_pk_bf16_f32 v237, v237, v237
    v_and_b32 v237, s69, v237
    v_sqrt_f32 v237, v237
    s_nop 0
    v_cvt_pk_bf16_f32 v237, v237, v237
    v_and_b32 v237, s69, v237
    v_rcp_f32 v35, v237
    v_sub_f32 v236, v33, v34
    v_cvt_pk_bf16_f32 v236, v236, v236
    v_and_b32 v236, s69, v236
    v_mul_f32 v236, v236, v35
    v_cvt_pk_bf16_f32 v236, v236, v236
    ds_write_b16 v14, v236
    v_mov_b32 v36, 0x3e0293ee
    s_add_u32 m0, s64, 32768
    s_xor_b32 s65, s62, 147456
    buffer_load_dwordx4 v176, s[20:23], s65 offen offset:0 nt lds
    s_waitcnt vmcnt(8)
    s_waitcnt vmcnt(5)
    s_waitcnt lgkmcnt(0)
    s_barrier
    ds_read_b128 v[200:203], v15 offset:0
    ds_read_b128 v[204:207], v15 offset:64
    ds_read_b64_tr_b16 v[64:65], v234 offset:0
    ds_read_b64_tr_b16 v[66:67], v234 offset:1024
    ds_read_b64_tr_b16 v[68:69], v234 offset:8192
    ds_read_b64_tr_b16 v[70:71], v234 offset:9216
    ds_read_b64_tr_b16 v[72:73], v229 offset:0
    ds_read_b64_tr_b16 v[74:75], v229 offset:1024
    ds_read_b64_tr_b16 v[76:77], v229 offset:8192
    ds_read_b64_tr_b16 v[78:79], v229 offset:9216
    s_waitcnt lgkmcnt(0)
    v_mfma_f32_16x16x32_bf16 v[216:219], v[200:203], v[64:67], 0
    v_mfma_f32_16x16x32_bf16 v[220:223], v[200:203], v[72:75], 0
    v_mfma_f32_16x16x32_bf16 v[216:219], v[204:207], v[68:71], v[216:219]
    v_mfma_f32_16x16x32_bf16 v[220:223], v[204:207], v[76:79], v[220:223]
    s_nop 7
    v_cvt_pk_bf16_f32 v244, v216, v220
    v_cvt_pk_bf16_f32 v48, v217, v221
    v_lshrrev_b32 v244, v39, v244
    v_lshl_or_b32 v228, v244, 16, v232
    buffer_store_dword v228, v233, s[44:47], 0 offen
    s_barrier
    s_add_u32 m0, s64, 36864
    s_xor_b32 s65, s62, 659456
    buffer_load_dwordx4 v176, s[20:23], s65 offen offset:0 nt lds
    s_add_u32 m0, s64, 40960
    s_xor_b32 s65, s62, 417792
    buffer_load_dwordx4 v176, s[20:23], s65 offen offset:0 nt lds
    s_add_u32 m0, s64, 45056
    s_xor_b32 s65, s62, 929792
    buffer_load_dwordx4 v176, s[20:23], s65 offen offset:0 nt lds
    s_add_u32 m0, s64, 49152
    s_xor_b32 s65, s62, 0
    buffer_load_dwordx4 v230, s[8:11], s65 offen offset:0 nt lds
    s_lshl_b32 s66, s48, 19
    s_load_dword s28, s[12:13], s66
    s_lshl_b32 s66, s48, 7
    s_load_dword s28, s[16:17], s66
    s_lshl_b32 s66, s48, 7
    s_load_dword s28, s[32:33], s66
    s_lshl_b32 s66, s48, 7
    s_load_dword s28, s[36:37], s66
    v_lshrrev_b32 v48, v39, v48
    v_min_u16 v48, v48, v40
    v_xor_b32 v208, v2, v3
    v_lshl_add_u32 v208, v2, 4, v208
    s_lshl_b32 s66, s52, 13
    s_add_u32 s66, s66, 16384
    v_lshl_add_u32 v208, v208, 4, s66
    v_xor_b32 v209, 64, v208
    v_xor_b32 v210, 128, v208
    v_xor_b32 v211, 192, v208
    v_mov_b32 v240, 1.0
    v_cmp_eq_u32 vcc, 0, v2
    s_nop 1
    v_cndmask_b32 v200, 0, v240, vcc
    v_cmp_eq_u32 vcc, 1, v2
    s_nop 1
    v_cndmask_b32 v201, 0, v240, vcc
    v_cmp_eq_u32 vcc, 2, v2
    s_nop 1
    v_cndmask_b32 v202, 0, v240, vcc
    v_cmp_eq_u32 vcc, 3, v2
    s_nop 1
    v_cndmask_b32 v203, 0, v240, vcc
    v_cmp_eq_u32 vcc, 4, v2
    s_nop 1
    v_cndmask_b32 v204, 0, v240, vcc
    v_cmp_eq_u32 vcc, 5, v2
    s_nop 1
    v_cndmask_b32 v205, 0, v240, vcc
    v_cmp_eq_u32 vcc, 6, v2
    s_nop 1
    v_cndmask_b32 v206, 0, v240, vcc
    v_cmp_eq_u32 vcc, 7, v2
    s_nop 1
    v_cndmask_b32 v207, 0, v240, vcc
    s_waitcnt vmcnt(5)
    s_add_u32 m0, s64, 53248
    s_xor_b32 s65, s62, 544768
    buffer_load_dwordx4 v230, s[8:11], s65 offen offset:0 nt lds
    s_add_u32 m0, s64, 57344
    s_xor_b32 s65, s62, 270336
    buffer_load_dwordx4 v230, s[8:11], s65 offen offset:0 nt lds
    s_add_u32 m0, s64, 61440
    s_xor_b32 s65, s62, 815104
    buffer_load_dwordx4 v230, s[8:11], s65 offen offset:0 nt lds
    s_add_u32 m0, s64, 81920
    s_add_u32 s65, s76, 0
    buffer_load_dwordx4 v37, s[12:15], s65 offen offset:0 nt lds
    v_lshrrev_b32 v237, 6, v0
    v_lshlrev_b32 v244, 2, v0
    v_add_u32 v244, 126208, v244
    v_mov_b32 v245, 0
    ds_write_b32 v244, v245
    v_mov_b32 v242, 125952
    v_lshlrev_b32 v240, 4, v3
    v_mul_u32_u24 v19, 288, v238
    v_add_u32 v19, v19, v240
    v_add_u32 v19, 123392, v19
    v_cmp_gt_u32 vcc, 32, v4
    v_mul_u32_u24 v244, 288, v237
    v_add_u32 v244, 123392, v244
    v_lshl_add_u32 v245, v2, 1, v3
    v_lshl_add_u32 v245, v245, 3, v244
    v_lshl_add_u32 v246, v2, 3, v242
    v_cndmask_b32 v18, v246, v245, vcc
    v_lshl_add_u32 v245, v3, 4, v2
    v_lshl_add_u32 v245, v245, 3, v244
    v_cndmask_b32 v235, v246, v245, vcc
    v_lshl_add_u32 v245, v237, 4, v2
    v_lshlrev_b32 v245, 1, v245
    v_add_u32 v245, 123136, v245
    v_cndmask_b32 v16, v246, v245, vcc
    v_lshl_add_u32 v244, v3, 2, v238
    v_lshlrev_b32 v244, 4, v244
    v_add_u32 v244, 124928, v244
    v_lshl_add_u32 v245, v237, 8, v244
    v_lshl_add_u32 v20, v239, 2, v245
    v_lshl_add_u32 v244, v239, 8, v244
    v_mov_b32 v28, v244
    v_mov_b32 v245, 123360
    v_cmp_eq_u32 vcc, 0, v239
    s_nop 1
    v_cndmask_b32 v24, v245, v244, vcc
    v_cmp_eq_u32 vcc, 1, v239
    s_nop 1
    v_cndmask_b32 v25, v245, v244, vcc
    v_cmp_eq_u32 vcc, 2, v239
    s_nop 1
    v_cndmask_b32 v26, v245, v244, vcc
    v_cmp_eq_u32 vcc, 3, v239
    s_nop 1
    v_cndmask_b32 v27, v245, v244, vcc
    v_lshl_add_u32 v244, v237, 2, v238
    v_lshlrev_b32 v244, 2, v244
    v_add_u32 v21, 123264, v244
    v_lshlrev_b32 v244, 2, v2
    v_add_u32 v22, 123264, v244
    v_cmp_gt_u32 vcc, 16, v4
    s_lshl_b32 s66, s51, 8
    v_add_u32 v244, s66, v1
    v_cndmask_b32 v10, v243, v244, vcc
    v_lshrrev_b32 v244, 1, v239
    v_and_b32 v245, 1, v3
    v_lshl_add_u32 v244, v245, 1, v244
    v_xor_b32 v244, v244, v237
    v_lshl_add_u32 v244, v244, 2, v238
    v_lshl_add_u32 v245, v3, 3, v239
    v_lshl_add_u32 v244, v245, 4, v244
    v_lshlrev_b32 v244, 3, v244
    v_add_u32 v23, 81920, v244
    v_lshl_add_u32 v245, v3, 2, v239
    v_and_b32 v244, 7, v245
    v_lshlrev_b32 v246, 1, v237
    v_xor_b32 v244, v244, v246
    v_lshl_add_u32 v244, v244, 2, v238
    v_lshl_add_u32 v244, v245, 5, v244
    v_lshlrev_b32 v244, 3, v244
    v_add_u32 v30, 49152, v244
    v_xor_b32 v31, 32, v30
    v_lshrrev_b32 v244, 1, v239
    v_lshl_add_u32 v244, v237, 1, v244
    v_lshl_add_u32 v244, v244, 2, v3
    v_and_b32 v245, 1, v239
    v_lshl_add_u32 v244, v244, 1, v245
    v_lshlrev_b32 v244, 2, v244
    v_lshl_add_u32 v244, v238, 13, v244
    s_lshl_b32 s66, s49, 8
    v_add_u32 v6, s66, v244
    s_lshl_b32 s66, s49, 4
    s_add_u32 s66, s66, 32768
    v_cmp_gt_u32 vcc, 4, v4
    v_lshl_add_u32 v244, v238, 9, s66
    s_nop 0
    v_cndmask_b32 v7, v243, v244, vcc
    s_lshl_b32 s66, s50, 9
    s_add_u32 s66, s66, 32768
    v_and_b32 v244, 1, v0
    v_lshl_add_u32 v244, v239, 1, v244
    v_and_b32 v245, 2, v0
    v_lshl_add_u32 v244, v244, 2, v245
    v_lshl_add_u32 v245, v237, 3, v3
    v_xor_b32 v244, v244, v245
    v_lshl_add_u32 v8, v244, 4, s66
    v_and_b32 v244, 31, v0
    v_cmp_eq_u32 vcc, 0, v244
    s_lshl_b32 s66, s50, 8
    s_add_u32 s66, s66, 36864
    v_lshl_add_u32 v12, v4, 2, s66
    s_lshl_b32 s67, s51, 2
    s_add_u32 s67, s67, s52
    s_lshl_b32 s74, s51, 3
    s_add_u32 s74, s74, s52
    s_lshl_b32 s74, s74, 11
    s_add_u32 s74, s74, 1310720
    s_lshl_b32 s67, s67, 2
    v_add_u32 v244, s67, v12
    v_cndmask_b32 v11, v243, v244, vcc
    v_and_b32 v244, 1, v0
    v_lshlrev_b32 v244, 4, v244
    v_mov_b32 v245, 0xffff
    v_lshlrev_b32 v244, v244, v245
    v_lshrrev_b32 v245, 1, v2
    v_cmp_eq_u32 vcc, 0, v245
    s_nop 1
    v_cndmask_b32 v52, 0, v244, vcc
    v_and_b32 v56, v60, v52
    v_cmp_eq_u32 vcc, 1, v245
    s_nop 1
    v_cndmask_b32 v53, 0, v244, vcc
    v_and_b32 v57, v60, v53
    v_cmp_eq_u32 vcc, 2, v245
    s_nop 1
    v_cndmask_b32 v54, 0, v244, vcc
    v_and_b32 v58, v60, v54
    v_cmp_eq_u32 vcc, 3, v245
    s_nop 1
    v_cndmask_b32 v55, 0, v244, vcc
    v_and_b32 v59, v60, v55
    s_lshl_b32 s66, s53, 6
    v_lshl_add_u32 v244, v3, 11, v2
    v_lshl_add_u32 v244, v244, 2, s66
    v_cmp_gt_u32 vcc, 32, v4
    v_lshrrev_b32 v245, 3, v4
    v_and_b32 v246, 1, v239
    v_cndmask_b32 v9, v243, v244, vcc
    v_lshl_add_u32 v245, v245, 4, v246
    v_lshl_add_u32 v245, v245, 9, v238
    v_lshl_add_u32 v49, v245, 4, s66
    s_branch L_page1
.p2align 12
L_page1:
    s_waitcnt vmcnt(6)
    s_waitcnt vmcnt(5)
    s_waitcnt vmcnt(5)
    buffer_load_dwordx4 v[184:187], v231, s[44:47], 0 offen offset:0 sc1
    buffer_load_dwordx4 v[188:191], v231, s[44:47], 0 offen offset:256 sc1
    buffer_load_dwordx4 v[192:195], v231, s[44:47], 0 offen offset:2048 sc1
    buffer_load_dwordx4 v[196:199], v231, s[44:47], 0 offen offset:2304 sc1
    s_barrier
    s_add_u32 m0, s64, 65536
    s_xor_b32 s65, s62, 147456
    buffer_load_dwordx4 v230, s[8:11], s65 offen offset:0 nt lds
    s_add_u32 m0, s64, 69632
    s_xor_b32 s65, s62, 659456
    buffer_load_dwordx4 v230, s[8:11], s65 offen offset:0 nt lds
    s_add_u32 m0, s64, 73728
    s_xor_b32 s65, s62, 417792
    buffer_load_dwordx4 v230, s[8:11], s65 offen offset:0 nt lds
    s_add_u32 m0, s64, 77824
    s_xor_b32 s65, s62, 929792
    buffer_load_dwordx4 v230, s[8:11], s65 offen offset:0 nt lds
    ds_read_b128 v[80:83], v208 offset:0
    ds_read_b128 v[84:87], v209 offset:0
    ds_read_b128 v[88:91], v210 offset:0
    ds_read_b128 v[92:95], v211 offset:0
    ds_read_b128 v[96:99], v208 offset:4096
    ds_read_b128 v[100:103], v209 offset:4096
    ds_read_b128 v[104:107], v210 offset:4096
    ds_read_b128 v[108:111], v211 offset:4096
    s_waitcnt vmcnt(4)
    s_mov_b32 s3, 0
L_a1chk:
    v_mfma_f32_16x16x32_bf16 v[216:219], v[200:203], v[184:187], 0
    v_mfma_f32_16x16x32_bf16 v[216:219], v[204:207], v[188:191], v[216:219]
    v_mfma_f32_16x16x32_bf16 v[216:219], v[200:203], v[192:195], v[216:219]
    v_mfma_f32_16x16x32_bf16 v[216:219], v[204:207], v[196:199], v[216:219]
    v_xor_b32 v241, s59, v184
    v_bitop3_b32 v241, v241, v185, s60 bitop3:0xf6
    v_bitop3_b32 v241, v241, v186, s59 bitop3:0xf6
    v_bitop3_b32 v241, v241, v187, s60 bitop3:0xf6
    v_bitop3_b32 v241, v241, v188, s59 bitop3:0xf6
    v_bitop3_b32 v241, v241, v189, s60 bitop3:0xf6
    v_bitop3_b32 v241, v241, v190, s59 bitop3:0xf6
    v_bitop3_b32 v241, v241, v191, s60 bitop3:0xf6
    v_bitop3_b32 v241, v241, v192, s59 bitop3:0xf6
    v_bitop3_b32 v241, v241, v193, s60 bitop3:0xf6
    v_bitop3_b32 v241, v241, v194, s59 bitop3:0xf6
    v_bitop3_b32 v241, v241, v195, s60 bitop3:0xf6
    v_bitop3_b32 v241, v241, v196, s59 bitop3:0xf6
    v_bitop3_b32 v241, v241, v197, s60 bitop3:0xf6
    v_bitop3_b32 v241, v241, v198, s59 bitop3:0xf6
    v_bitop3_b32 v241, v241, v199, s60 bitop3:0xf6
    v_cvt_pk_bf16_f32 v244, v216, v217
    v_cvt_pk_bf16_f32 v245, v218, v219
    ds_write_b64 v235, v[244:245]
    v_and_b32 v242, 0xfff0, v241
    v_cmp_ne_u32 s[80:81], 0, v242
    v_and_b32 v242, 15, v241
    v_cmp_ne_u32 vcc, 0, v242
    s_lshl_b32 s66, s52, 2
    s_add_u32 s66, s66, 123328
    v_mov_b32 v242, s66
    s_cmp_lg_u64 vcc, 0
    s_cselect_b32 s66, 1, 0
    s_cmp_lg_u64 s[80:81], 0
    s_cselect_b32 s66, 2, s66
    v_mov_b32 v243, s66
    ds_write_b32 v242, v243
    v_mov_b32 v242, 123328
    s_waitcnt lgkmcnt(0)
    s_barrier
    ds_read_b128 v[244:247], v242
    s_waitcnt lgkmcnt(0)
    v_or3_b32 v244, v244, v245, v246
    v_or_b32 v244, v244, v247
    s_nop 0
    v_readfirstlane_b32 s66, v244
    s_cmp_eq_u32 s66, 0
    s_cbranch_scc1 L_body_near
    s_add_u32 s3, s3, 1
    s_mov_b32 s65, 0
    s_cmp_eq_u32 s66, 1
    s_cbranch_scc1 L_a1wt
    s_cmp_lt_u32 s3, 4
    s_cbranch_scc1 L_a1again
L_a1wt:
    s_mov_b32 s65, 1835008
    buffer_store_dword v228, v233, s[44:47], s65 offen sc1
    s_cmp_eq_u32 s66, 1
    s_cbranch_scc1 L_body_far
    s_bitcmp1_b32 s3, 0
    s_cselect_b32 s65, 0, s65
L_a1again:
    s_sub_u32 s61, s61, 1
    s_cbranch_scc1 L_end
    buffer_load_dwordx4 v[184:187], v231, s[44:47], s65 offen offset:0 sc1
    buffer_load_dwordx4 v[188:191], v231, s[44:47], s65 offen offset:256 sc1
    buffer_load_dwordx4 v[192:195], v231, s[44:47], s65 offen offset:2048 sc1
    buffer_load_dwordx4 v[196:199], v231, s[44:47], s65 offen offset:2304 sc1
    s_barrier
    s_waitcnt vmcnt(0)
    s_branch L_a1chk
L_body_near:
    ds_read_b128 v[200:203], v19 offset:0
    ds_read_b128 v[204:207], v19 offset:64
    ds_read_b128 v[208:211], v19 offset:128
    ds_read_b128 v[212:215], v19 offset:192
    v_mov_b32 v184, -1
    v_mov_b32 v185, -1
    v_lshlrev_b32 v250, 3, v0
    s_lshl_b32 s66, s49, 11
    s_add_u32 s66, s66, s63
    s_add_u32 s66, s66, 34816
    s_cmp_lt_u32 s49, 27
    s_cselect_b32 s66, s66, 1073741824
    buffer_store_dwordx2 v[184:185], v250, s[44:47], s66 offen offset:0
    s_barrier
    s_add_u32 m0, s64, 86016
    s_add_u32 s65, s76, 32768
    buffer_load_dwordx4 v37, s[12:15], s65 offen offset:0 nt lds
    s_add_u32 m0, s64, 90112
    s_add_u32 s65, s76, 65536
    buffer_load_dwordx4 v37, s[12:15], s65 offen offset:0 nt lds
    s_add_u32 m0, s64, 94208
    s_add_u32 s65, s76, 98304
    buffer_load_dwordx4 v37, s[12:15], s65 offen offset:0 nt lds
    s_waitcnt lgkmcnt(3)
    v_mfma_f32_16x16x32_bf16 v[216:219], v[80:83], v[200:203], 0
    s_waitcnt lgkmcnt(2)
    v_mfma_f32_16x16x32_bf16 v[216:219], v[84:87], v[204:207], v[216:219]
    s_waitcnt lgkmcnt(1)
    v_mfma_f32_16x16x32_bf16 v[216:219], v[88:91], v[208:211], v[216:219]
    s_waitcnt lgkmcnt(0)
    v_mfma_f32_16x16x32_bf16 v[216:219], v[92:95], v[212:215], v[216:219]
    v_mfma_f32_16x16x32_bf16 v[220:223], v[96:99], v[200:203], 0
    v_mfma_f32_16x16x32_bf16 v[220:223], v[100:103], v[204:207], v[220:223]
    v_mfma_f32_16x16x32_bf16 v[220:223], v[104:107], v[208:211], v[220:223]
    v_mfma_f32_16x16x32_bf16 v[220:223], v[108:111], v[212:215], v[220:223]
    s_nop 3
    v_max3_f32 v236, v216, v217, v218
    v_mov_b32_dpp v216, v218 quad_perm:[0,1,2,3] row_mask:0xf bank_mask:0x2
    v_mov_b32_dpp v217, v219 quad_perm:[0,1,2,3] row_mask:0xf bank_mask:0x2
    v_max_f32 v236, v236, v219
    v_max3_f32 v236, v236, v220, v221
    v_max3_f32 v237, v236, v222, v223
    v_max3_f32 v236, v236, v222, v223
    v_mov_b32_dpp v216, v220 quad_perm:[0,1,2,3] row_mask:0xf bank_mask:0x4
    v_mov_b32_dpp v217, v221 quad_perm:[0,1,2,3] row_mask:0xf bank_mask:0x4
    v_permlane32_swap_b32 v236, v237
    v_max_f32 v236, v236, v237
    v_mov_b32 v237, v236
    v_mov_b32_dpp v216, v222 quad_perm:[0,1,2,3] row_mask:0xf bank_mask:0x8
    v_mov_b32_dpp v217, v223 quad_perm:[0,1,2,3] row_mask:0xf bank_mask:0x8
    v_permlane16_swap_b32 v236, v237
    v_max_f32 v236, v236, v237
    v_mul_f32 v236, v236, v36
    v_fma_f32 v216, v216, v36, -v236
    v_fma_f32 v217, v217, v36, -v236
    v_exp_f32 v216, v216
    v_exp_f32 v217, v217
    ds_write_b32 v21, v236
    v_cvt_pk_bf16_f32 v216, v216, v217
    ds_write_b32 v20, v216
    buffer_load_dword v51, off, s[16:19], s77 nt
    buffer_load_dword v51, off, s[32:35], s77 nt
    buffer_load_dword v51, off, s[36:39], s79 nt
    v_cmp_gt_u32 vcc, 8, v4
    v_mov_b32 v50, 1073741824
    v_not_b32 v224, s55
    v_not_b32 v225, s56
    v_not_b32 v226, s57
    v_not_b32 v227, s58
    v_cndmask_b32 v50, v50, v49, vcc
    s_add_u32 s67, s74, 131072
    buffer_store_dwordx4 v[224:227], v50, s[44:47], s67 offen sc1
    s_waitcnt vmcnt(17)
    s_waitcnt lgkmcnt(0)
    s_barrier
    ds_read_b32 v239, v22
    ds_read_b128 v[200:203], v24
    ds_read_b128 v[232:235], v28
    ds_read_b128 v[204:207], v25
    ds_read_b128 v[208:211], v26
    ds_read_b128 v[212:215], v27
    s_waitcnt lgkmcnt(0)
    ds_read_b64_tr_b16 v[112:113], v30 offset:0
    ds_read_b64_tr_b16 v[114:115], v30 offset:4096
    ds_read_b64_tr_b16 v[128:129], v31 offset:0
    ds_read_b64_tr_b16 v[130:131], v31 offset:4096
    ds_read_b64_tr_b16 v[116:117], v30 offset:8192
    ds_read_b64_tr_b16 v[118:119], v30 offset:12288
    ds_read_b64_tr_b16 v[132:133], v31 offset:8192
    ds_read_b64_tr_b16 v[134:135], v31 offset:12288
    v_mfma_f32_16x16x32_bf16 v[224:227], v[60:63], v[232:235], 0
    v_max_f32_dpp v42, v239, v239 row_ror:8
    s_nop 1
    v_max_f32_dpp v42, v42, v42 row_ror:4
    v_sub_f32 v240, v239, v42
    v_exp_f32 v240, v240
    s_nop 1
    v_mul_f32 v44, v224, v240
    s_nop 1
    v_add_f32_dpp v44, v44, v44 row_ror:8
    s_nop 1
    v_add_f32_dpp v44, v44, v44 row_ror:4
    s_waitcnt lgkmcnt(4)
    v_mfma_f32_16x16x32_bf16 v[216:219], v[112:115], v[200:203], 0
    v_mfma_f32_16x16x32_bf16 v[220:223], v[128:131], v[200:203], 0
    s_waitcnt lgkmcnt(0)
    v_mfma_f32_16x16x32_bf16 v[216:219], v[116:119], v[204:207], v[216:219]
    v_mfma_f32_16x16x32_bf16 v[220:223], v[132:135], v[204:207], v[220:223]
    s_waitcnt vmcnt(7)
    s_waitcnt vmcnt(8)
    s_barrier
    ds_read_b64_tr_b16 v[120:121], v30 offset:16384
    ds_read_b64_tr_b16 v[122:123], v30 offset:20480
    ds_read_b64_tr_b16 v[136:137], v31 offset:16384
    ds_read_b64_tr_b16 v[138:139], v31 offset:20480
    ds_read_b64_tr_b16 v[124:125], v30 offset:24576
    ds_read_b64_tr_b16 v[126:127], v30 offset:28672
    ds_read_b64_tr_b16 v[140:141], v31 offset:24576
    ds_read_b64_tr_b16 v[142:143], v31 offset:28672
    s_waitcnt lgkmcnt(4)
    v_mfma_f32_16x16x32_bf16 v[216:219], v[120:123], v[208:211], v[216:219]
    v_mfma_f32_16x16x32_bf16 v[220:223], v[136:139], v[208:211], v[220:223]
    s_waitcnt lgkmcnt(0)
    v_mfma_f32_16x16x32_bf16 v[216:219], v[124:127], v[212:215], v[216:219]
    v_mfma_f32_16x16x32_bf16 v[220:223], v[140:143], v[212:215], v[220:223]
    s_nop 6
    v_pk_mul_f32 v[216:217], v[216:217], v[240:241] op_sel_hi:[1,0]
    v_pk_mul_f32 v[218:219], v[218:219], v[240:241] op_sel_hi:[1,0]
    v_pk_mul_f32 v[220:221], v[220:221], v[240:241] op_sel_hi:[1,0]
    v_pk_mul_f32 v[222:223], v[222:223], v[240:241] op_sel_hi:[1,0]
    v_add_f32_dpp v244, v216, v216 row_ror:8 row_mask:0xf bank_mask:0x3
    v_add_f32_dpp v245, v217, v217 row_ror:8 row_mask:0xf bank_mask:0x3
    v_add_f32_dpp v246, v218, v218 row_ror:8 row_mask:0xf bank_mask:0x3
    v_add_f32_dpp v247, v219, v219 row_ror:8 row_mask:0xf bank_mask:0x3
    v_add_f32_dpp v244, v220, v220 row_ror:8 row_mask:0xf bank_mask:0xc
    v_add_f32_dpp v245, v221, v221 row_ror:8 row_mask:0xf bank_mask:0xc
    v_add_f32_dpp v246, v222, v222 row_ror:8 row_mask:0xf bank_mask:0xc
    v_add_f32_dpp v247, v223, v223 row_ror:8 row_mask:0xf bank_mask:0xc
    v_add_f32_dpp v248, v244, v244 row_shl:4 row_mask:0xf bank_mask:0x5
    v_add_f32_dpp v249, v245, v245 row_shl:4 row_mask:0xf bank_mask:0x5
    s_nop 0
    v_add_f32_dpp v248, v246, v246 row_shr:4 row_mask:0xf bank_mask:0xa
    v_add_f32_dpp v249, v247, v247 row_shr:4 row_mask:0xf bank_mask:0xa
    v_cvt_pk_bf16_f32 v248, v248, v249
    v_min_u32 v248, s70, v248
    buffer_store_dword v248, v6, s[44:47], s63 offen offset:0
    s_barrier
    s_cmp_lg_u32 s52, 3
    s_cbranch_scc1 L_m1_near
    buffer_store_dwordx4 v[42:45], v7, s[44:47], s63 offen offset:0
L_m1_near:
    buffer_load_dwordx4 v[192:195], v8, s[44:47], s63 offen offset:0 sc1
    s_nop 7
    s_nop 7
    s_nop 7
    buffer_load_dwordx4 v[196:199], v8, s[44:47], s63 offen offset:0 sc1
    s_branch L_sg3_near
L_b6_near:
    buffer_load_dwordx4 v[184:187], v1, s[44:47], s75 offen offset:0 sc1
    buffer_load_dwordx4 v[188:191], v1, s[44:47], s75 offen offset:1024 sc1
    s_sub_u32 s61, s61, 1
    s_cbranch_scc1 L_end
    s_waitcnt vmcnt(0)
    s_branch L_a5_near
L_i11_near:
    buffer_load_dwordx4 v[184:187], v1, s[44:47], s75 offen offset:0 sc1
    buffer_load_dwordx4 v[188:191], v1, s[44:47], s75 offen offset:1024 sc1
    v_mov_b32 v236, v196
    v_mov_b32 v237, v198
    s_branch L_go4_near
L_s2_near:
    buffer_load_dwordx4 v[192:195], v8, s[44:47], s63 offen offset:0 sc1
    s_sub_u32 s61, s61, 1
    s_cbranch_scc1 L_end
    s_waitcnt vmcnt(1)
    v_xor_b32 v243, s54, v197
    v_bitop3_b32 v243, v243, v199, s54 bitop3:0xf6
    v_cmp_ne_u32 vcc, 0, v243
    s_cbranch_vccz L_i11_near
    buffer_load_dwordx4 v[196:199], v8, s[44:47], s63 offen offset:0 sc1
L_sg3_near:
    s_waitcnt vmcnt(1)
    v_xor_b32 v243, s54, v193
    v_bitop3_b32 v243, v243, v195, s54 bitop3:0xf6
    v_cmp_ne_u32 vcc, 0, v243
    s_cbranch_vccnz L_s2_near
    buffer_load_dwordx4 v[184:187], v1, s[44:47], s75 offen offset:0 sc1
    buffer_load_dwordx4 v[188:191], v1, s[44:47], s75 offen offset:1024 sc1
    v_mov_b32 v236, v192
    v_mov_b32 v237, v194
L_go4_near:
    s_barrier
    s_add_u32 m0, s64, 98304
    s_nop 0
    buffer_load_dwordx4 v38, s[16:19], s77 offen offset:0 nt lds
    s_add_u32 m0, s64, 102400
    s_nop 0
    buffer_load_dwordx4 v38, s[16:19], s78 offen offset:0 nt lds
    s_add_u32 m0, s64, 106496
    s_nop 0
    buffer_load_dwordx4 v38, s[32:35], s77 offen offset:0 nt lds
    ds_read_b64_tr_b16 v[144:145], v23 offset:0
    ds_read_b64_tr_b16 v[146:147], v23 offset:512
    ds_read_b64_tr_b16 v[148:149], v23 offset:4096
    ds_read_b64_tr_b16 v[150:151], v23 offset:4608
    ds_read_b64_tr_b16 v[152:153], v23 offset:8192
    ds_read_b64_tr_b16 v[154:155], v23 offset:8704
    ds_read_b64_tr_b16 v[156:157], v23 offset:12288
    ds_read_b64_tr_b16 v[158:159], v23 offset:12800
    v_max_f32_dpp v242, v236, v236 quad_perm:[1,0,3,2]
    s_nop 1
    v_max_f32_dpp v242, v242, v242 quad_perm:[2,3,0,1]
    s_nop 1
    v_max_f32_dpp v242, v242, v242 row_ror:4
    s_nop 1
    v_max_f32_dpp v242, v242, v242 row_ror:8
    v_mov_b32 v243, v242
    s_nop 1
    v_permlane16_swap_b32 v242, v243
    v_max_f32 v242, v242, v243
    v_sub_f32 v236, v236, v242
    v_exp_f32 v236, v236
    s_nop 0
    v_cvt_pk_bf16_f32 v236, v236, v236
    v_and_b32 v242, s69, v236
    v_mul_f32 v237, v237, v242
    v_and_b32_dpp v228, v236, v52 row_newbcast:0
    v_and_b32_dpp v229, v236, v53 row_newbcast:0
    v_add_f32_dpp v237, v237, v237 quad_perm:[1,0,3,2]
    v_and_b32_dpp v230, v236, v54 row_newbcast:0
    v_and_b32_dpp v231, v236, v55 row_newbcast:0
    v_add_f32_dpp v237, v237, v237 quad_perm:[2,3,0,1]
    v_and_b32_dpp v232, v236, v52 row_newbcast:1
    v_and_b32_dpp v233, v236, v53 row_newbcast:1
    v_add_f32_dpp v237, v237, v237 row_ror:4
    v_and_b32_dpp v234, v236, v54 row_newbcast:1
    v_and_b32_dpp v235, v236, v55 row_newbcast:1
    v_add_f32_dpp v237, v237, v237 row_ror:8
    v_mov_b32 v242, v237
    s_nop 1
    v_permlane16_swap_b32 v237, v242
    v_add_f32 v237, v237, v242
    v_rcp_f32 v237, v237
L_a5_near:
    s_waitcnt vmcnt(4)
    v_mfma_f32_16x16x32_bf16 v[216:219], v[228:231], v[184:187], 0
    v_max3_u32 v243, v184, v185, v186
    s_waitcnt vmcnt(3)
    v_mfma_f32_16x16x32_bf16 v[216:219], v[232:235], v[188:191], v[216:219]
    v_max3_u32 v243, v243, v187, v188
    v_max3_u32 v243, v243, v189, v190
    v_max_u32 v243, v243, v191
    v_cmp_eq_u32 vcc, -1, v243
    s_cbranch_vccnz L_b6_near
    s_nop 2
    v_cvt_pk_bf16_f32 v244, v216, v217
    v_cvt_pk_bf16_f32 v245, v218, v219
    ds_write_b64 v18, v[244:245]
    ds_write_b32 v21, v60 offset:2944
    s_barrier
    ds_read_b32 v251, v22 offset:2944
    ds_read_b128 v[200:203], v19 offset:0
    ds_read_b128 v[204:207], v19 offset:64
    ds_read_b128 v[208:211], v19 offset:128
    ds_read_b128 v[212:215], v19 offset:192
L_t12_near:
    s_waitcnt lgkmcnt(3)
    v_cmp_eq_u32 vcc, 0, v251
    v_mfma_f32_16x16x32_bf16 v[216:219], v[200:203], v[144:147], 0
    s_cbranch_vccnz L_u13_near
    s_waitcnt lgkmcnt(2)
    v_mfma_f32_16x16x32_bf16 v[216:219], v[204:207], v[148:151], v[216:219]
    s_waitcnt lgkmcnt(1)
    v_mfma_f32_16x16x32_bf16 v[216:219], v[208:211], v[152:155], v[216:219]
    s_waitcnt lgkmcnt(0)
    v_mfma_f32_16x16x32_bf16 v[216:219], v[212:215], v[156:159], v[216:219]
    s_nop 7
    v_pk_add_f32 v[244:245], v[216:217], v[218:219]
    v_add_f32 v244, v244, v245
    v_mul_f32 v244, v244, v237
    v_and_or_b32 v244, v244, s71, v32
    buffer_store_dword v244, v9, s[44:47], s74 offen offset:0 sc1
    s_add_u32 s74, s74, 131072
    s_add_u32 m0, s64, 110592
    s_nop 0
    buffer_load_dwordx4 v38, s[32:35], s78 offen offset:0 nt lds
    v_lshlrev_b32 v250, 3, v0
    s_lshl_b32 s66, s49, 11
    s_add_u32 s66, s66, s63
    s_add_u32 s66, s66, 34816
    s_cmp_lt_u32 s49, 27
    s_cselect_b32 s66, s66, 1073741824
    buffer_load_dwordx2 v[198:199], v250, s[44:47], s66 offen nt
    s_add_u32 s76, s75, 40960
    buffer_store_short v48, v5, s[44:47], s63 offen offset:2048
    s_cmp_eq_u32 s48, 0
    s_cbranch_scc1 L_g014_near
    s_add_u32 m0, s64, 114688
    s_add_u32 s65, s79, 0
    buffer_load_dwordx4 v37, s[36:39], s65 offen offset:0 nt lds
    s_add_u32 m0, s64, 118784
    s_add_u32 s65, s79, 32768
    buffer_load_dwordx4 v37, s[36:39], s65 offen offset:0 nt lds
    s_lshl_b32 s66, s53, 6
    s_add_u32 s66, s66, s74
    s_add_u32 s66, s66, 0
    s_add_u32 s67, s66, 8192
    s_mov_b32 s28, s54
    s_waitcnt lgkmcnt(0)
    s_load_dword s29, s[44:45], s67 glc
    s_load_dword s28, s[44:45], s66 glc
    s_waitcnt lgkmcnt(1)
    s_nop 3
    s_cmp_eq_u32 s28, s54
    s_cselect_b32 s3, 1, 0
    s_cselect_b32 s72, 8192, 0
    s_add_u32 s72, s72, s74
    s_sub_u32 s72, s72, 131072
    s_waitcnt vmcnt(4)
    buffer_load_dwordx4 v[184:187], v1, s[44:47], s72 offen offset:0 sc1
    buffer_load_dwordx4 v[188:191], v1, s[44:47], s72 offen offset:1024 sc1
    s_waitcnt vmcnt(6)
    s_barrier
    ds_read_b64_tr_b16 v[160:161], v23 offset:16384
    ds_read_b64_tr_b16 v[162:163], v23 offset:16896
    ds_read_b64_tr_b16 v[164:165], v23 offset:20480
    ds_read_b64_tr_b16 v[166:167], v23 offset:20992
    ds_read_b64_tr_b16 v[168:169], v23 offset:24576
    ds_read_b64_tr_b16 v[170:171], v23 offset:25088
    ds_read_b64_tr_b16 v[172:173], v23 offset:28672
    ds_read_b64_tr_b16 v[174:175], v23 offset:29184
    s_branch L_g17_near
L_r16_near:
    buffer_load_dwordx4 v[184:187], v1, s[44:47], s72 offen offset:0 sc1
    buffer_load_dwordx4 v[188:191], v1, s[44:47], s72 offen offset:1024 sc1
    s_sub_u32 s61, s61, 1
    s_cbranch_scc1 L_end
L_g17_near:
    s_waitcnt vmcnt(1)
    v_xor_b32 v184, s55, v184
    v_xor_b32 v185, s56, v185
    v_xor_b32 v186, s57, v186
    v_xor_b32 v187, s58, v187
    v_or3_b32 v238, v184, v185, v186
    s_waitcnt vmcnt(0)
    v_xor_b32 v188, s55, v188
    v_xor_b32 v190, s57, v190
    v_add_f32 v244, v184, v188
    v_add_f32 v246, v186, v190
    v_xor_b32 v189, s56, v189
    v_xor_b32 v191, s58, v191
    v_permlane32_swap_b32 v244, v246
    v_add_f32 v245, v185, v189
    v_add_f32 v247, v187, v191
    v_add_f32 v244, v244, v246
    v_or3_b32 v238, v238, v187, v188
    v_permlane32_swap_b32 v245, v247
    v_add_f32 v245, v245, v247
    v_or3_b32 v238, v238, v189, v190
    v_or_b32 v238, v238, v191
    v_permlane16_swap_b32 v244, v245
    v_add_f32 v244, v244, v245
    v_and_b32 v238, 0xff, v238
    v_cmp_ne_u32 vcc, 0, v238
    v_add_f32_dpp v244, v244, v244 row_ror:8
    s_cbranch_vccnz L_r16_near
    s_nop 0
    v_add_f32_dpp v244, v244, v244 row_ror:4
    v_cvt_pk_bf16_f32 v244, v244, v244
    v_and_b32 v244, s69, v244
    v_add_f32 v244, v244, v33
    v_cvt_pk_bf16_f32 v237, v244, v244
    ds_write_b16 v14, v237
    s_add_u32 s72, s72, 131072
    v_and_b32 v33, s69, v237
    v_and_b32 v239, s69, v237
    v_mul_f32 v240, v33, v33
    s_nop 1
    v_permlane32_swap_b32 v239, v240
    v_add_f32 v239, v239, v240
    v_mov_b32 v240, v239
    s_nop 1
    v_permlane16_swap_b32 v239, v240
    v_add_f32 v239, v239, v240
    s_nop 1
    v_add_f32_dpp v239, v239, v239 quad_perm:[1,0,3,2]
    s_nop 1
    v_add_f32_dpp v239, v239, v239 quad_perm:[2,3,0,1]
    v_and_or_b32 v239, v239, -4, s3
    buffer_store_dword v239, v11, s[44:47], s63 offen offset:0
    s_waitcnt lgkmcnt(0)
    s_barrier
    ds_read_b128 v[200:203], v15 offset:0
    ds_read_b128 v[204:207], v15 offset:64
L_t18_near:
    s_waitcnt lgkmcnt(1)
    v_mfma_f32_16x16x32_bf16 v[216:219], v[200:203], v[160:163], 0
    v_mfma_f32_16x16x32_bf16 v[220:223], v[200:203], v[168:171], 0
    s_waitcnt lgkmcnt(0)
    v_mfma_f32_16x16x32_bf16 v[216:219], v[204:207], v[164:167], v[216:219]
    v_mfma_f32_16x16x32_bf16 v[220:223], v[204:207], v[172:175], v[220:223]
    buffer_load_dword v192, v12, s[44:47], s63 offen offset:0 sc1
    s_nop 6
    buffer_store_dwordx4 v[218:221], v10, s[44:47], s76 offen offset:0
    s_nop 7
    buffer_load_dword v196, v12, s[44:47], s63 offen offset:0 sc1
    s_branch L_sg21_near
L_b24_near:
    buffer_load_dwordx4 v[184:187], v1, s[44:47], s76 offen offset:0 sc1
    buffer_load_dwordx4 v[188:191], v1, s[44:47], s76 offen offset:1024 sc1
    s_sub_u32 s61, s61, 1
    s_cbranch_scc1 L_end
    s_branch L_a23_near
L_i29_near:
    buffer_load_dwordx4 v[184:187], v1, s[44:47], s76 offen offset:0 sc1
    buffer_load_dwordx4 v[188:191], v1, s[44:47], s76 offen offset:1024 sc1
    v_and_b32 v236, -4, v196
    v_and_b32 v237, -4, v196
    s_branch L_go22_near
L_s20_near:
    buffer_load_dword v192, v12, s[44:47], s63 offen offset:0 sc1
    s_sub_u32 s61, s61, 1
    s_cbranch_scc1 L_end
    s_waitcnt vmcnt(1)
    v_cmp_eq_u32 vcc, -1, v196
    s_cbranch_vccz L_i29_near
    buffer_load_dword v196, v12, s[44:47], s63 offen offset:0 sc1
    s_waitcnt vmcnt(1)
L_sg21_near:
    s_waitcnt vmcnt(2)
    v_cmp_eq_u32 vcc, -1, v192
    s_cbranch_vccnz L_s20_near
    buffer_load_dwordx4 v[184:187], v1, s[44:47], s76 offen offset:0 sc1
    buffer_load_dwordx4 v[188:191], v1, s[44:47], s76 offen offset:1024 sc1
    v_and_b32 v236, -4, v192
    v_and_b32 v237, -4, v192
L_go22_near:
    ds_read_b64_tr_b16 v[176:177], v23 offset:32768
    ds_read_b64_tr_b16 v[178:179], v23 offset:33280
    ds_read_b64_tr_b16 v[180:181], v23 offset:36864
    ds_read_b64_tr_b16 v[182:183], v23 offset:37376
    v_permlane16_swap_b32 v236, v237
    v_add_f32 v236, v236, v237
    s_nop 1
    v_add_f32_dpp v236, v236, v236 row_ror:8
    s_nop 1
    v_add_f32_dpp v236, v236, v236 row_ror:4
    s_nop 1
    v_add_f32_dpp v236, v236, v236 quad_perm:[2,3,0,1]
    s_nop 1
    v_add_f32_dpp v236, v236, v236 quad_perm:[1,0,3,2]
    v_mul_f32 v236, 0x3b000000, v236
    v_mov_b32 v237, v236
    s_nop 1
    v_permlane32_swap_b32 v236, v237
    v_cvt_pk_bf16_f32 v34, v236, v236
    v_and_b32 v34, s69, v34
    v_fma_f32 v237, -v236, v236, v237
    v_max_f32 v237, 0, v237
    v_cvt_pk_bf16_f32 v237, v237, v237
    v_and_b32 v237, s69, v237
    v_add_f32 v237, 0x3727c5ac, v237
    v_cvt_pk_bf16_f32 v237, v237, v237
    v_and_b32 v237, s69, v237
    v_sqrt_f32 v237, v237
    s_nop 0
    v_cvt_pk_bf16_f32 v237, v237, v237
    v_and_b32 v237, s69, v237
    v_rcp_f32 v35, v237
    s_nop 0
    v_mul_f32 v241, 0xbfb8aa3b, v35
L_a23_near:
    s_waitcnt vmcnt(1)
    v_fma_f32 v244, -v34, v185, v184
    v_fma_f32 v245, -v34, v187, v186
    v_max3_u32 v238, v184, v185, v186
    s_waitcnt vmcnt(0)
    v_add_f32 v244, v244, v188
    v_add_f32 v245, v245, v190
    v_fma_f32 v244, -v34, v189, v244
    v_fma_f32 v245, -v34, v191, v245
    v_max3_u32 v238, v238, v187, v188
    v_max3_u32 v238, v238, v189, v190
    v_permlane32_swap_b32 v244, v245
    v_add_f32 v244, v244, v245
    v_mov_b32 v245, v244
    v_max_u32 v238, v238, v191
    v_cmp_eq_u32 vcc, -1, v238
    v_permlane16_swap_b32 v244, v245
    s_cbranch_vccnz L_b24_near
    v_add_f32 v244, v244, v245
    v_mul_f32 v246, v244, v241
    v_mul_f32 v244, v244, v35
    v_exp_f32 v246, v246
    v_mov_b32 v247, v244
    v_add_f32 v246, 1.0, v246
    v_rcp_f32 v246, v246
    v_permlane32_swap_b32 v244, v247
    v_mul_f32 v246, v246, v244
    v_mul_f32 v246, v246, v247
    v_cvt_pk_bf16_f32 v246, v246, v246
    ds_write_b16 v16, v246
    s_waitcnt lgkmcnt(0)
    s_barrier
    ds_read_b128 v[200:203], v17 offset:0
    ds_read_b128 v[204:207], v17 offset:64
    s_add_u32 s67, s63, 36864
    buffer_load_dwordx4 v[192:195], v1, s[44:47], s67 offen offset:0 sc1
L_t30_near:
    s_waitcnt lgkmcnt(1)
    v_mfma_f32_16x16x32_bf16 v[216:219], v[200:203], v[176:179], 0
    s_waitcnt lgkmcnt(0)
    v_mfma_f32_16x16x32_bf16 v[216:219], v[204:207], v[180:183], v[216:219]
    s_nop 7
    v_and_or_b32 v244, v216, s71, v32
    buffer_store_dword v244, v9, s[44:47], s74 offen offset:0 sc1
    s_add_u32 s74, s74, 131072
    v_cmp_gt_u32 vcc, 16, v4
    v_mov_b32 v50, 1073741824
    v_not_b32 v224, s55
    v_not_b32 v225, s56
    v_not_b32 v226, s57
    v_not_b32 v227, s58
    v_cndmask_b32 v50, v50, v49, vcc
    s_add_u32 s67, s74, 0
    buffer_store_dwordx4 v[224:227], v50, s[44:47], s67 offen sc1
    s_waitcnt vmcnt(2)
    v_and_b32 v236, 3, v192
    v_and_b32 v237, 3, v193
    v_and_b32 v238, 3, v194
    v_and_b32 v239, 3, v195
    v_cmp_eq_u32 vcc, 1, v236
    s_nop 0
    s_bcnt1_i32_b64 s67, vcc
    s_add_u32 s66, s67, 0
    v_cmp_eq_u32 vcc, 1, v237
    s_nop 0
    s_bcnt1_i32_b64 s67, vcc
    s_add_u32 s66, s67, s66
    v_cmp_eq_u32 vcc, 1, v238
    s_nop 0
    s_bcnt1_i32_b64 s67, vcc
    s_add_u32 s66, s67, s66
    v_cmp_eq_u32 vcc, 1, v239
    s_nop 0
    s_bcnt1_i32_b64 s67, vcc
    s_add_u32 s66, s67, s66
    s_cmp_ge_u32 s66, 48
    s_cselect_b32 s72, 8192, 0
    s_add_u32 s72, s72, s74
    s_sub_u32 s72, s72, 131072
    v_add_f32 v236, v185, v189
    v_add_f32 v237, v187, v191
    v_and_b32 v238, 7, v0
    v_and_b32 v239, 1, v3
    v_permlane32_swap_b32 v236, v237
    v_add_f32 v236, v236, v237
    v_mov_b32 v237, v236
    v_lshl_add_u32 v238, v238, 1, v239
    v_and_or_b32 v239, v0, 32, v238
    v_permlane16_swap_b32 v236, v237
    v_add_f32 v236, v236, v237
    v_lshlrev_b32 v239, 2, v239
    v_sub_u32 v238, v238, v2
    ds_bpermute_b32 v46, v239, v236
    v_lshl_add_u32 v16, v238, 1, v16
    v_lshrrev_b32 v10, 1, v10
    s_lshl_b32 s76, s53, 2
    s_add_u32 s76, s76, s52
    s_lshl_b32 s76, s76, 10
    s_add_u32 s76, s76, 65536
    v_mov_b32 v240, -1
    v_mov_b32 v241, -1
    buffer_store_dwordx2 v[240:241], v10, s[44:47], s76 offen offset:0
L_join15_near:
    s_branch L_page2
.p2align 12
L_page2:
    buffer_load_dwordx4 v[200:203], v1, s[44:47], s73 offen offset:2048 sc1
    buffer_load_dwordx4 v[204:207], v1, s[44:47], s73 offen offset:3072 sc1
    v_mov_b32 v228, -1
    v_mov_b32 v229, -1
    v_mov_b32 v230, -1
    v_mov_b32 v231, -1
    v_lshrrev_b32 v232, 2, v1
    s_lshl_b32 s62, s52, 5
    s_add_u32 s62, s62, s49
    s_lshl_b32 s62, s62, 8
    s_add_u32 s62, s62, s63
    buffer_store_dword v228, v232, s[44:47], s62 offen offset:0
    s_sub_u32 s78, s52, s50
    s_lshl_b32 s78, s78, 8
    s_add_u32 s78, s78, s63
    s_waitcnt vmcnt(0)
    buffer_load_dwordx4 v[184:187], v1, s[44:47], s72 offen offset:0 sc1
    buffer_load_dwordx4 v[188:191], v1, s[44:47], s72 offen offset:1024 sc1
    s_branch L_g33_near
L_r32_near:
    buffer_load_dwordx4 v[200:203], v1, s[44:47], s73 offen offset:2048 sc1
    buffer_load_dwordx4 v[204:207], v1, s[44:47], s73 offen offset:3072 sc1
    s_waitcnt vmcnt(0)
    s_sub_u32 s61, s61, 1
    s_cbranch_scc1 L_end
L_g33_near:
    s_waitcnt vmcnt(3)
    v_mfma_f32_16x16x32_bf16 v[216:219], v[56:59], v[200:203], 0
    v_max3_u32 v239, v200, v201, v202
    s_waitcnt vmcnt(2)
    v_mfma_f32_16x16x32_bf16 v[216:219], v[56:59], v[204:207], v[216:219]
    v_max3_u32 v239, v239, v203, v204
    v_max3_u32 v239, v239, v205, v206
    v_max_u32 v239, v239, v207
    v_cmp_eq_u32 vcc, -1, v239
    s_cbranch_vccnz L_r32_near
    s_nop 2
    v_mov_b32 v48, v216
    v_mov_b32 v49, v217
    v_mov_b32 v50, v218
    v_mov_b32 v51, v219
    s_branch L_g35_near
L_r34_near:
    buffer_load_dwordx4 v[184:187], v1, s[44:47], s72 offen offset:0 sc1
    buffer_load_dwordx4 v[188:191], v1, s[44:47], s72 offen offset:1024 sc1
    s_sub_u32 s61, s61, 1
    s_cbranch_scc1 L_end
L_g35_near:
    s_waitcnt vmcnt(1)
    v_xor_b32 v184, s55, v184
    v_xor_b32 v185, s56, v185
    v_xor_b32 v186, s57, v186
    v_xor_b32 v187, s58, v187
    v_or3_b32 v238, v184, v185, v186
    s_waitcnt vmcnt(0)
    v_xor_b32 v188, s55, v188
    v_xor_b32 v190, s57, v190
    v_add_f32 v244, v184, v188
    v_add_f32 v246, v186, v190
    v_xor_b32 v189, s56, v189
    v_xor_b32 v191, s58, v191
    v_permlane32_swap_b32 v244, v246
    v_add_f32 v245, v185, v189
    v_add_f32 v247, v187, v191
    v_add_f32 v244, v244, v246
    v_or3_b32 v238, v238, v187, v188
    v_permlane32_swap_b32 v245, v247
    v_add_f32 v245, v245, v247
    v_or3_b32 v238, v238, v189, v190
    v_or_b32 v238, v238, v191
    v_permlane16_swap_b32 v244, v245
    v_add_f32 v244, v244, v245
    v_and_b32 v238, 0xff, v238
    v_cmp_ne_u32 vcc, 0, v238
    v_add_f32_dpp v244, v244, v244 row_ror:8
    s_cbranch_vccnz L_r34_near
    s_nop 0
    v_add_f32_dpp v244, v244, v244 row_ror:4
    v_cvt_pk_bf16_f32 v244, v244, v244
    v_and_b32 v244, s69, v244
    v_add_f32 v244, v244, v33
    v_cvt_pk_bf16_f32 v237, v244, v244
    ds_write_b16 v14, v237
    s_add_u32 s72, s72, 131072
    v_and_b32 v33, s69, v237
    v_and_b32 v239, s69, v237
    v_mul_f32 v240, v33, v33
    s_nop 1
    v_permlane32_swap_b32 v239, v240
    v_add_f32 v239, v239, v240
    v_mov_b32 v240, v239
    s_nop 1
    v_permlane16_swap_b32 v239, v240
    v_add_f32 v239, v239, v240
    s_nop 1
    v_add_f32_dpp v239, v239, v239 quad_perm:[1,0,3,2]
    s_nop 1
    v_add_f32_dpp v239, v239, v239 quad_perm:[2,3,0,1]
    v_and_or_b32 v239, v239, -4, s3
    buffer_store_dword v239, v11, s[44:47], s63 offen offset:2048
    s_waitcnt lgkmcnt(0)
    s_barrier
    ds_read_b128 v[200:203], v15 offset:0
    ds_read_b128 v[204:207], v15 offset:64
L_t36_near:
    s_waitcnt lgkmcnt(1)
    v_mfma_f32_16x16x32_bf16 v[216:219], v[200:203], v[64:67], 0
    v_mfma_f32_16x16x32_bf16 v[220:223], v[200:203], v[72:75], 0
    s_waitcnt lgkmcnt(0)
    v_mfma_f32_16x16x32_bf16 v[216:219], v[204:207], v[68:71], v[216:219]
    v_mfma_f32_16x16x32_bf16 v[220:223], v[204:207], v[76:79], v[220:223]
    buffer_load_dword v192, v12, s[44:47], s78 offen offset:2048 sc1
    s_nop 6
    v_cvt_pk_bf16_f32 v244, v216, v220
    v_lshrrev_b32 v244, v39, v244
    v_min_u16 v244, v244, v40
    buffer_store_short v244, v5, s[44:47], s63 offen offset:0
    s_nop 7
    buffer_load_dword v196, v12, s[44:47], s78 offen offset:2048 sc1
    s_branch L_sg39_near
L_b42_near:
    buffer_load_dwordx4 v[184:187], v1, s[44:47], s73 offen offset:0 sc1
    buffer_load_dwordx4 v[188:191], v1, s[44:47], s73 offen offset:1024 sc1
    s_sub_u32 s61, s61, 1
    s_cbranch_scc1 L_end
    s_branch L_a41_near
L_i47_near:
    buffer_load_dwordx4 v[184:187], v1, s[44:47], s73 offen offset:0 sc1
    buffer_load_dwordx4 v[188:191], v1, s[44:47], s73 offen offset:1024 sc1
    v_and_b32 v236, -4, v196
    v_and_b32 v237, -4, v196
    s_branch L_go40_near
L_s38_near:
    buffer_load_dword v192, v12, s[44:47], s78 offen offset:2048 sc1
    s_sub_u32 s61, s61, 1
    s_cbranch_scc1 L_end
    s_waitcnt vmcnt(1)
    v_cmp_eq_u32 vcc, -1, v196
    s_cbranch_vccz L_i47_near
    buffer_load_dword v196, v12, s[44:47], s78 offen offset:2048 sc1
    s_waitcnt vmcnt(1)
L_sg39_near:
    s_waitcnt vmcnt(2)
    v_cmp_eq_u32 vcc, -1, v192
    s_cbranch_vccnz L_s38_near
    buffer_load_dwordx4 v[184:187], v1, s[44:47], s73 offen offset:0 sc1
    buffer_load_dwordx4 v[188:191], v1, s[44:47], s73 offen offset:1024 sc1
    v_and_b32 v236, -4, v192
    v_and_b32 v237, -4, v192
L_go40_near:
    s_nop 1
    v_permlane16_swap_b32 v236, v237
    v_add_f32 v236, v236, v237
    s_nop 1
    v_add_f32_dpp v236, v236, v236 row_ror:8
    s_nop 1
    v_add_f32_dpp v236, v236, v236 row_ror:4
    s_nop 1
    v_add_f32_dpp v236, v236, v236 quad_perm:[2,3,0,1]
    s_nop 1
    v_add_f32_dpp v236, v236, v236 quad_perm:[1,0,3,2]
    v_mul_f32 v236, 0x3b000000, v236
    v_mov_b32 v237, v236
    s_nop 1
    v_permlane32_swap_b32 v236, v237
    v_cvt_pk_bf16_f32 v34, v236, v236
    v_and_b32 v34, s69, v34
    v_fma_f32 v237, -v236, v236, v237
    v_max_f32 v237, 0, v237
    v_cvt_pk_bf16_f32 v237, v237, v237
    v_and_b32 v237, s69, v237
    v_add_f32 v237, 0x3727c5ac, v237
    v_cvt_pk_bf16_f32 v237, v237, v237
    v_and_b32 v237, s69, v237
    v_sqrt_f32 v237, v237
    s_nop 0
    v_cvt_pk_bf16_f32 v237, v237, v237
    v_and_b32 v237, s69, v237
    v_rcp_f32 v35, v237
    v_mul_f32_e64 v224, -v34, v48
    v_mul_f32_e64 v225, -v34, v49
    v_mul_f32_e64 v226, -v34, v50
    v_mul_f32_e64 v227, -v34, v51
    v_mul_f32 v36, v36, v35
L_a41_near:
    s_waitcnt vmcnt(1)
    v_mfma_f32_16x16x32_bf16 v[216:219], v[56:59], v[184:187], v[224:227]
    v_max3_u32 v238, v184, v185, v186
    s_waitcnt vmcnt(0)
    v_mfma_f32_16x16x32_bf16 v[216:219], v[56:59], v[188:191], v[216:219]
    v_max3_u32 v238, v238, v187, v188
    v_max3_u32 v238, v238, v189, v190
    v_max_u32 v238, v238, v191
    v_cmp_eq_u32 vcc, -1, v238
    s_cbranch_vccnz L_b42_near
    s_nop 2
    v_cvt_pk_bf16_f32 v244, v216, v217
    v_cvt_pk_bf16_f32 v245, v218, v219
    ds_write_b64 v18, v[244:245]
    ds_write_b32 v21, v60 offset:3200
    s_barrier
    ds_read_b32 v251, v22 offset:3200
    ds_read_b128 v[200:203], v19 offset:0
    ds_read_b128 v[204:207], v19 offset:64
    ds_read_b128 v[208:211], v19 offset:128
    ds_read_b128 v[212:215], v19 offset:192
L_t48_near:
    s_waitcnt lgkmcnt(3)
    v_cmp_eq_u32 vcc, 0, v251
    v_mfma_f32_16x16x32_bf16 v[216:219], v[80:83], v[200:203], 0
    s_cbranch_vccnz L_u49_near
    s_waitcnt lgkmcnt(2)
    v_mfma_f32_16x16x32_bf16 v[216:219], v[84:87], v[204:207], v[216:219]
    s_waitcnt lgkmcnt(1)
    v_mfma_f32_16x16x32_bf16 v[216:219], v[88:91], v[208:211], v[216:219]
    s_waitcnt lgkmcnt(0)
    v_mfma_f32_16x16x32_bf16 v[216:219], v[92:95], v[212:215], v[216:219]
    v_mfma_f32_16x16x32_bf16 v[220:223], v[96:99], v[200:203], 0
    v_mfma_f32_16x16x32_bf16 v[220:223], v[100:103], v[204:207], v[220:223]
    v_mfma_f32_16x16x32_bf16 v[220:223], v[104:107], v[208:211], v[220:223]
    v_mfma_f32_16x16x32_bf16 v[220:223], v[108:111], v[212:215], v[220:223]
    s_nop 3
    v_max3_f32 v236, v216, v217, v218
    v_mov_b32_dpp v216, v218 quad_perm:[0,1,2,3] row_mask:0xf bank_mask:0x2
    v_mov_b32_dpp v217, v219 quad_perm:[0,1,2,3] row_mask:0xf bank_mask:0x2
    v_max_f32 v236, v236, v219
    v_max3_f32 v236, v236, v220, v221
    v_max3_f32 v237, v236, v222, v223
    v_max3_f32 v236, v236, v222, v223
    v_mov_b32_dpp v216, v220 quad_perm:[0,1,2,3] row_mask:0xf bank_mask:0x4
    v_mov_b32_dpp v217, v221 quad_perm:[0,1,2,3] row_mask:0xf bank_mask:0x4
    v_permlane32_swap_b32 v236, v237
    v_max_f32 v236, v236, v237
    v_mov_b32 v237, v236
    v_mov_b32_dpp v216, v222 quad_perm:[0,1,2,3] row_mask:0xf bank_mask:0x8
    v_mov_b32_dpp v217, v223 quad_perm:[0,1,2,3] row_mask:0xf bank_mask:0x8
    v_permlane16_swap_b32 v236, v237
    v_max_f32 v236, v236, v237
    v_mul_f32 v236, v236, v36
    v_fma_f32 v216, v216, v36, -v236
    v_fma_f32 v217, v217, v36, -v236
    v_exp_f32 v216, v216
    v_exp_f32 v217, v217
    v_and_or_b32 v236, v236, -4, 1
    v_cvt_pk_bf16_f32 v216, v216, v217
    ds_write_b32 v20, v216
    ds_write_b32 v21, v236 offset:3264
    s_barrier
    ds_read_b32 v239, v22 offset:3264
    ds_read_b128 v[200:203], v24
    ds_read_b128 v[232:235], v28
    ds_read_b128 v[204:207], v25
    ds_read_b128 v[208:211], v26
    ds_read_b128 v[212:215], v27
L_t50_near:
    s_waitcnt lgkmcnt(4)
    v_cmp_eq_u32 vcc, 0, v239
    v_mfma_f32_16x16x32_bf16 v[216:219], v[112:115], v[200:203], 0
    s_cbranch_vccnz L_u51_near
    v_mfma_f32_16x16x32_bf16 v[220:223], v[128:131], v[200:203], 0
    s_waitcnt lgkmcnt(3)
    v_mfma_f32_16x16x32_bf16 v[224:227], v[60:63], v[232:235], 0
    s_waitcnt lgkmcnt(2)
    v_mfma_f32_16x16x32_bf16 v[216:219], v[116:119], v[204:207], v[216:219]
    v_mfma_f32_16x16x32_bf16 v[220:223], v[132:135], v[204:207], v[220:223]
    s_waitcnt lgkmcnt(1)
    v_mfma_f32_16x16x32_bf16 v[216:219], v[120:123], v[208:211], v[216:219]
    v_mfma_f32_16x16x32_bf16 v[220:223], v[136:139], v[208:211], v[220:223]
    s_waitcnt lgkmcnt(0)
    v_mfma_f32_16x16x32_bf16 v[216:219], v[124:127], v[212:215], v[216:219]
    v_max_f32_dpp v42, v239, v239 row_ror:8
    v_mfma_f32_16x16x32_bf16 v[220:223], v[140:143], v[212:215], v[220:223]
    s_nop 0
    v_max_f32_dpp v42, v42, v42 row_ror:4
    v_sub_f32 v240, v239, v42
    v_exp_f32 v240, v240
    s_nop 0
    v_mul_f32 v44, v224, v240
    s_nop 1
    v_add_f32_dpp v44, v44, v44 row_ror:8
    v_pk_mul_f32 v[216:217], v[216:217], v[240:241] op_sel_hi:[1,0]
    v_pk_mul_f32 v[218:219], v[218:219], v[240:241] op_sel_hi:[1,0]
    v_pk_mul_f32 v[220:221], v[220:221], v[240:241] op_sel_hi:[1,0]
    v_pk_mul_f32 v[222:223], v[222:223], v[240:241] op_sel_hi:[1,0]
    v_add_f32_dpp v44, v44, v44 row_ror:4
    buffer_store_dwordx4 v[42:45], v7, s[44:47], s63 offen offset:2048
    v_add_f32_dpp v244, v216, v216 row_ror:8 row_mask:0xf bank_mask:0x3
    v_add_f32_dpp v245, v217, v217 row_ror:8 row_mask:0xf bank_mask:0x3
    v_add_f32_dpp v246, v218, v218 row_ror:8 row_mask:0xf bank_mask:0x3
    v_add_f32_dpp v247, v219, v219 row_ror:8 row_mask:0xf bank_mask:0x3
    v_add_f32_dpp v244, v220, v220 row_ror:8 row_mask:0xf bank_mask:0xc
    v_add_f32_dpp v245, v221, v221 row_ror:8 row_mask:0xf bank_mask:0xc
    v_add_f32_dpp v246, v222, v222 row_ror:8 row_mask:0xf bank_mask:0xc
    v_add_f32_dpp v247, v223, v223 row_ror:8 row_mask:0xf bank_mask:0xc
    v_add_f32_dpp v248, v244, v244 row_shl:4 row_mask:0xf bank_mask:0x5
    v_add_f32_dpp v249, v245, v245 row_shl:4 row_mask:0xf bank_mask:0x5
    s_nop 0
    v_add_f32_dpp v248, v246, v246 row_shr:4 row_mask:0xf bank_mask:0xa
    v_add_f32_dpp v249, v247, v247 row_shr:4 row_mask:0xf bank_mask:0xa
    v_cvt_pk_bf16_f32 v248, v248, v249
    v_min_u32 v248, s70, v248
    buffer_store_dword v248, v6, s[44:47], s63 offen offset:0
    buffer_load_dwordx4 v[192:195], v8, s[44:47], s63 offen offset:2048 sc1
    s_nop 7
    s_nop 7
    s_nop 7
    buffer_load_dwordx4 v[196:199], v8, s[44:47], s63 offen offset:2048 sc1
    s_branch L_sg54_near
L_b57_near:
    buffer_load_dwordx4 v[184:187], v1, s[44:47], s75 offen offset:0 sc1
    buffer_load_dwordx4 v[188:191], v1, s[44:47], s75 offen offset:1024 sc1
    s_sub_u32 s61, s61, 1
    s_cbranch_scc1 L_end
    s_branch L_a56_near
L_i62_near:
    buffer_load_dwordx4 v[184:187], v1, s[44:47], s75 offen offset:0 sc1
    buffer_load_dwordx4 v[188:191], v1, s[44:47], s75 offen offset:1024 sc1
    v_mov_b32 v236, v196
    v_mov_b32 v237, v198
    s_branch L_go55_near
L_s53_near:
    buffer_load_dwordx4 v[192:195], v8, s[44:47], s63 offen offset:2048 sc1
    s_sub_u32 s61, s61, 1
    s_cbranch_scc1 L_end
    s_waitcnt vmcnt(1)
    v_xor_b32 v243, s54, v197
    v_bitop3_b32 v243, v243, v199, s54 bitop3:0xf6
    v_cmp_ne_u32 vcc, 0, v243
    s_cbranch_vccz L_i62_near
    buffer_load_dwordx4 v[196:199], v8, s[44:47], s63 offen offset:2048 sc1
L_sg54_near:
    s_waitcnt vmcnt(1)
    v_xor_b32 v243, s54, v193
    v_bitop3_b32 v243, v243, v195, s54 bitop3:0xf6
    v_cmp_ne_u32 vcc, 0, v243
    s_cbranch_vccnz L_s53_near
    buffer_load_dwordx4 v[184:187], v1, s[44:47], s75 offen offset:0 sc1
    buffer_load_dwordx4 v[188:191], v1, s[44:47], s75 offen offset:1024 sc1
    v_mov_b32 v236, v192
    v_mov_b32 v237, v194
L_go55_near:
    s_nop 0
    v_max_f32_dpp v242, v236, v236 quad_perm:[1,0,3,2]
    s_nop 1
    v_max_f32_dpp v242, v242, v242 quad_perm:[2,3,0,1]
    s_nop 1
    v_max_f32_dpp v242, v242, v242 row_ror:4
    s_nop 1
    v_max_f32_dpp v242, v242, v242 row_ror:8
    v_mov_b32 v243, v242
    s_nop 1
    v_permlane16_swap_b32 v242, v243
    v_max_f32 v242, v242, v243
    v_sub_f32 v236, v236, v242
    v_exp_f32 v236, v236
    s_nop 0
    v_cvt_pk_bf16_f32 v236, v236, v236
    v_and_b32 v242, s69, v236
    v_mul_f32 v237, v237, v242
    v_and_b32_dpp v228, v236, v52 row_newbcast:0
    v_and_b32_dpp v229, v236, v53 row_newbcast:0
    v_add_f32_dpp v237, v237, v237 quad_perm:[1,0,3,2]
    v_and_b32_dpp v230, v236, v54 row_newbcast:0
    v_and_b32_dpp v231, v236, v55 row_newbcast:0
    v_add_f32_dpp v237, v237, v237 quad_perm:[2,3,0,1]
    v_and_b32_dpp v232, v236, v52 row_newbcast:1
    v_and_b32_dpp v233, v236, v53 row_newbcast:1
    v_add_f32_dpp v237, v237, v237 row_ror:4
    v_and_b32_dpp v234, v236, v54 row_newbcast:1
    v_and_b32_dpp v235, v236, v55 row_newbcast:1
    v_add_f32_dpp v237, v237, v237 row_ror:8
    v_mov_b32 v242, v237
    s_nop 1
    v_permlane16_swap_b32 v237, v242
    v_add_f32 v237, v237, v242
    v_rcp_f32 v237, v237
L_a56_near:
    s_waitcnt vmcnt(1)
    v_mfma_f32_16x16x32_bf16 v[216:219], v[228:231], v[184:187], 0
    v_max3_u32 v243, v184, v185, v186
    s_waitcnt vmcnt(0)
    v_mfma_f32_16x16x32_bf16 v[216:219], v[232:235], v[188:191], v[216:219]
    v_max3_u32 v243, v243, v187, v188
    v_max3_u32 v243, v243, v189, v190
    v_max_u32 v243, v243, v191
    v_cmp_eq_u32 vcc, -1, v243
    s_cbranch_vccnz L_b57_near
    s_nop 2
    v_cvt_pk_bf16_f32 v244, v216, v217
    v_cvt_pk_bf16_f32 v245, v218, v219
    ds_write_b64 v18, v[244:245]
    ds_write_b32 v21, v60 offset:3328
    s_barrier
    ds_read_b32 v251, v22 offset:3328
    ds_read_b128 v[200:203], v19 offset:0
    ds_read_b128 v[204:207], v19 offset:64
    ds_read_b128 v[208:211], v19 offset:128
    ds_read_b128 v[212:215], v19 offset:192
L_t63_near:
    s_waitcnt lgkmcnt(3)
    v_cmp_eq_u32 vcc, 0, v251
    v_mfma_f32_16x16x32_bf16 v[216:219], v[200:203], v[144:147], 0
    s_cbranch_vccnz L_u64_near
    s_waitcnt lgkmcnt(2)
    v_mfma_f32_16x16x32_bf16 v[216:219], v[204:207], v[148:151], v[216:219]
    s_waitcnt lgkmcnt(1)
    v_mfma_f32_16x16x32_bf16 v[216:219], v[208:211], v[152:155], v[216:219]
    s_waitcnt lgkmcnt(0)
    v_mfma_f32_16x16x32_bf16 v[216:219], v[212:215], v[156:159], v[216:219]
    s_nop 7
    v_pk_add_f32 v[244:245], v[216:217], v[218:219]
    v_add_f32 v244, v244, v245
    v_mul_f32 v244, v244, v237
    v_and_or_b32 v244, v244, s71, v32
    buffer_store_dword v244, v9, s[44:47], s74 offen offset:0 sc1
    s_add_u32 s74, s74, 131072
    s_cmp_eq_u32 s48, 0
    s_cbranch_scc1 L_tag_near
    s_branch L_page3
.p2align 12
L_page3:
    s_waitcnt vmcnt(0)
    buffer_load_dwordx4 v[184:187], v1, s[44:47], s72 offen offset:0 sc1
    buffer_load_dwordx4 v[188:191], v1, s[44:47], s72 offen offset:1024 sc1
    s_branch L_g66_near
L_r65_near:
    buffer_load_dwordx4 v[184:187], v1, s[44:47], s72 offen offset:0 sc1
    buffer_load_dwordx4 v[188:191], v1, s[44:47], s72 offen offset:1024 sc1
    s_sub_u32 s61, s61, 1
    s_cbranch_scc1 L_end
L_g66_near:
    s_waitcnt vmcnt(1)
    v_xor_b32 v184, s55, v184
    v_xor_b32 v185, s56, v185
    v_xor_b32 v186, s57, v186
    v_xor_b32 v187, s58, v187
    v_or3_b32 v238, v184, v185, v186
    s_waitcnt vmcnt(0)
    v_xor_b32 v188, s55, v188
    v_xor_b32 v190, s57, v190
    v_add_f32 v244, v184, v188
    v_add_f32 v246, v186, v190
    v_xor_b32 v189, s56, v189
    v_xor_b32 v191, s58, v191
    v_permlane32_swap_b32 v244, v246
    v_add_f32 v245, v185, v189
    v_add_f32 v247, v187, v191
    v_add_f32 v244, v244, v246
    v_or3_b32 v238, v238, v187, v188
    v_permlane32_swap_b32 v245, v247
    v_add_f32 v245, v245, v247
    v_or3_b32 v238, v238, v189, v190
    v_or_b32 v238, v238, v191
    v_permlane16_swap_b32 v244, v245
    v_add_f32 v244, v244, v245
    v_and_b32 v238, 0xff, v238
    v_cmp_ne_u32 vcc, 0, v238
    v_add_f32_dpp v244, v244, v244 row_ror:8
    s_cbranch_vccnz L_r65_near
    s_nop 0
    v_add_f32_dpp v244, v244, v244 row_ror:4
    v_cvt_pk_bf16_f32 v244, v244, v244
    v_and_b32 v244, s69, v244
    v_add_f32 v244, v244, v33
    v_cvt_pk_bf16_f32 v237, v244, v244
    ds_write_b16 v14, v237
    s_add_u32 s72, s72, 131072
    v_and_b32 v33, s69, v237
    v_and_b32 v239, s69, v237
    v_mul_f32 v240, v33, v33
    s_nop 1
    v_permlane32_swap_b32 v239, v240
    v_add_f32 v239, v239, v240
    v_mov_b32 v240, v239
    s_nop 1
    v_permlane16_swap_b32 v239, v240
    v_add_f32 v239, v239, v240
    s_nop 1
    v_add_f32_dpp v239, v239, v239 quad_perm:[1,0,3,2]
    s_nop 1
    v_add_f32_dpp v239, v239, v239 quad_perm:[2,3,0,1]
    v_and_or_b32 v239, v239, -4, s3
    buffer_store_dword v239, v11, s[44:47], s63 offen offset:1024
    s_waitcnt lgkmcnt(0)
    s_barrier
    ds_read_b128 v[200:203], v15 offset:0
    ds_read_b128 v[204:207], v15 offset:64
L_t67_near:
    s_waitcnt lgkmcnt(1)
    v_mfma_f32_16x16x32_bf16 v[216:219], v[200:203], v[160:163], 0
    v_mfma_f32_16x16x32_bf16 v[220:223], v[200:203], v[168:171], 0
    s_waitcnt lgkmcnt(0)
    v_mfma_f32_16x16x32_bf16 v[216:219], v[204:207], v[164:167], v[216:219]
    v_mfma_f32_16x16x32_bf16 v[220:223], v[204:207], v[172:175], v[220:223]
    buffer_load_dword v192, v12, s[44:47], s63 offen offset:1024 sc1
    s_nop 6
    v_mov_b32 v217, v220
    buffer_store_dwordx2 v[216:217], v10, s[44:47], s76 offen offset:0
    s_nop 7
    buffer_load_dword v196, v12, s[44:47], s63 offen offset:1024 sc1
    s_branch L_sg70_near
L_b73_near:
    buffer_load_dwordx4 v[184:187], v1, s[44:47], s76 offen offset:0 sc1
    s_sub_u32 s61, s61, 1
    s_cbranch_scc1 L_end
    s_branch L_a72_near
L_i78_near:
    buffer_load_dwordx4 v[184:187], v1, s[44:47], s76 offen offset:0 sc1
    v_and_b32 v236, -4, v196
    v_and_b32 v237, -4, v196
    s_branch L_go71_near
L_s69_near:
    buffer_load_dword v192, v12, s[44:47], s63 offen offset:1024 sc1
    s_sub_u32 s61, s61, 1
    s_cbranch_scc1 L_end
    s_waitcnt vmcnt(1)
    v_cmp_eq_u32 vcc, -1, v196
    s_cbranch_vccz L_i78_near
    buffer_load_dword v196, v12, s[44:47], s63 offen offset:1024 sc1
    s_waitcnt vmcnt(1)
L_sg70_near:
    s_waitcnt vmcnt(2)
    v_cmp_eq_u32 vcc, -1, v192
    s_cbranch_vccnz L_s69_near
    buffer_load_dwordx4 v[184:187], v1, s[44:47], s76 offen offset:0 sc1
    v_and_b32 v236, -4, v192
    v_and_b32 v237, -4, v192
L_go71_near:
    s_nop 1
    v_permlane16_swap_b32 v236, v237
    v_add_f32 v236, v236, v237
    s_nop 1
    v_add_f32_dpp v236, v236, v236 row_ror:8
    s_nop 1
    v_add_f32_dpp v236, v236, v236 row_ror:4
    s_nop 1
    v_add_f32_dpp v236, v236, v236 quad_perm:[2,3,0,1]
    s_nop 1
    v_add_f32_dpp v236, v236, v236 quad_perm:[1,0,3,2]
    v_mul_f32 v236, 0x3b000000, v236
    v_mov_b32 v237, v236
    s_nop 1
    v_permlane32_swap_b32 v236, v237
    v_cvt_pk_bf16_f32 v34, v236, v236
    v_and_b32 v34, s69, v34
    v_fma_f32 v237, -v236, v236, v237
    v_max_f32 v237, 0, v237
    v_cvt_pk_bf16_f32 v237, v237, v237
    v_and_b32 v237, s69, v237
    v_add_f32 v237, 0x3727c5ac, v237
    v_cvt_pk_bf16_f32 v237, v237, v237
    v_and_b32 v237, s69, v237
    v_sqrt_f32 v237, v237
    s_nop 0
    v_cvt_pk_bf16_f32 v237, v237, v237
    v_and_b32 v237, s69, v237
    v_rcp_f32 v35, v237
    v_mul_f32_e64 v243, -v34, v46
    v_mul_f32 v241, 0xbfb8aa3b, v35
    v_mul_f32 v242, v243, v35
    v_mul_f32 v243, v243, v241
L_a72_near:
    s_waitcnt vmcnt(0)
    v_permlane32_swap_b32 v184, v185
    v_permlane32_swap_b32 v186, v187
    v_add_f32 v244, v184, v185
    v_add_f32 v245, v186, v187
    v_max3_u32 v238, v184, v185, v186
    v_max_u32 v238, v238, v187
    v_permlane16_swap_b32 v244, v245
    v_add_f32 v244, v244, v245
    v_cmp_eq_u32 vcc, -1, v238
    s_cbranch_vccnz L_b73_near
    v_add_f32_dpp v244, v244, v244 row_ror:8
    v_fma_f32 v246, v244, v241, v243
    v_fma_f32 v244, v244, v35, v242
    v_exp_f32 v246, v246
    v_mov_b32 v247, v244
    v_add_f32 v246, 1.0, v246
    v_rcp_f32 v246, v246
    v_permlane32_swap_b32 v244, v247
    v_mul_f32 v246, v246, v244
    v_mul_f32 v246, v246, v247
    v_cvt_pk_bf16_f32 v246, v246, v246
    ds_write_b16 v16, v246
    s_waitcnt lgkmcnt(0)
    s_barrier
    ds_read_b128 v[200:203], v17 offset:0
    ds_read_b128 v[204:207], v17 offset:64
L_t79_near:
    s_waitcnt lgkmcnt(1)
    v_mfma_f32_16x16x32_bf16 v[216:219], v[200:203], v[176:179], 0
    s_waitcnt lgkmcnt(0)
    v_mfma_f32_16x16x32_bf16 v[216:219], v[204:207], v[180:183], v[216:219]
    s_nop 7
    v_and_or_b32 v244, v216, s71, v32
    buffer_store_dword v244, v9, s[44:47], s74 offen offset:0 sc1
    s_add_u32 s74, s74, 131072
    s_add_u32 s66, s52, 20
    s_cmp_lg_u32 s53, s66
    s_cbranch_scc1 L_fin_near
    s_waitcnt vmcnt(0)
    buffer_load_dwordx4 v[184:187], v1, s[44:47], s72 offen offset:0 sc1
    buffer_load_dwordx4 v[188:191], v1, s[44:47], s72 offen offset:1024 sc1
    s_branch L_g82_near
L_r81_near:
    buffer_load_dwordx4 v[184:187], v1, s[44:47], s72 offen offset:0 sc1
    buffer_load_dwordx4 v[188:191], v1, s[44:47], s72 offen offset:1024 sc1
    s_sub_u32 s61, s61, 1
    s_cbranch_scc1 L_end
L_g82_near:
    s_waitcnt vmcnt(1)
    v_xor_b32 v184, s55, v184
    v_xor_b32 v185, s56, v185
    v_xor_b32 v186, s57, v186
    v_xor_b32 v187, s58, v187
    v_or3_b32 v238, v184, v185, v186
    s_waitcnt vmcnt(0)
    v_xor_b32 v188, s55, v188
    v_xor_b32 v190, s57, v190
    v_add_f32 v244, v184, v188
    v_add_f32 v246, v186, v190
    v_xor_b32 v189, s56, v189
    v_xor_b32 v191, s58, v191
    v_permlane32_swap_b32 v244, v246
    v_add_f32 v245, v185, v189
    v_add_f32 v247, v187, v191
    v_add_f32 v244, v244, v246
    v_or3_b32 v238, v238, v187, v188
    v_permlane32_swap_b32 v245, v247
    v_add_f32 v245, v245, v247
    v_or3_b32 v238, v238, v189, v190
    v_or_b32 v238, v238, v191
    v_permlane16_swap_b32 v244, v245
    v_add_f32 v244, v244, v245
    v_and_b32 v238, 0xff, v238
    v_cmp_ne_u32 vcc, 0, v238
    v_add_f32_dpp v244, v244, v244 row_ror:8
    s_cbranch_vccnz L_r81_near
    s_nop 0
    v_add_f32_dpp v244, v244, v244 row_ror:4
    v_cvt_pk_bf16_f32 v244, v244, v244
    v_and_b32 v244, s69, v244
    v_add_f32 v244, v244, v33
    v_cvt_pk_bf16_f32 v237, v244, v244
    s_add_u32 s72, s72, 131072
    buffer_store_short v237, v13, s[40:43], 0 offen
L_fin_near:
    s_endpgm
L_tag_near:
    s_cmp_lg_u32 s49, 0
    s_cbranch_scc1 L_fin_near
    v_cmp_eq_u32 vcc, 0, v0
    v_mov_b32 v238, 1073741824
    v_mov_b32 v239, s54
    v_cndmask_b32_e64 v238, v238, 0, vcc
    buffer_store_dword v239, v238, s[44:47], 0 offen sc1
    s_branch L_fin_near
L_g014_near:
    buffer_store_dword v32, v9, s[44:47], s74 offen offset:0 sc1
    v_cmp_gt_u32 vcc, 8, v4
    v_mov_b32 v50, 1073741824
    v_not_b32 v224, s55
    v_not_b32 v225, s56
    v_not_b32 v226, s57
    v_not_b32 v227, s58
    v_cndmask_b32 v50, v50, v49, vcc
    s_add_u32 s67, s74, 131072
    buffer_store_dwordx4 v[224:227], v50, s[44:47], s67 offen sc1
    s_lshl_b32 s66, s53, 6
    s_add_u32 s66, s66, s74
    s_add_u32 s66, s66, 0
    s_add_u32 s67, s66, 8192
    s_load_dword s28, s[44:45], s66 glc
    s_load_dword s29, s[44:45], s67 glc
    s_waitcnt lgkmcnt(0)
    s_memtime s[80:81]
    s_load_dword s28, s[44:45], s66 glc
    s_waitcnt lgkmcnt(0)
    s_mov_b32 s66, s80
    s_memtime s[80:81]
    s_load_dword s28, s[44:45], s67 glc
    s_waitcnt lgkmcnt(0)
    s_mov_b32 s67, s80
    s_memtime s[80:81]
    s_sub_u32 s66, s67, s66
    s_waitcnt lgkmcnt(0)
    s_sub_u32 s67, s80, s67
    s_cmp_gt_u32 s66, s67
    s_cselect_b32 s3, 1, 0
    s_cselect_b32 s72, 8192, 0
    s_add_u32 s72, s72, s74
    s_sub_u32 s72, s72, 131072
    s_add_u32 s74, s74, 131072
    s_waitcnt vmcnt(0)
    buffer_load_dwordx4 v[184:187], v1, s[44:47], s72 offen offset:0 sc1
    buffer_load_dwordx4 v[188:191], v1, s[44:47], s72 offen offset:1024 sc1
    s_branch L_g84_near
L_r83_near:
    buffer_load_dwordx4 v[184:187], v1, s[44:47], s72 offen offset:0 sc1
    buffer_load_dwordx4 v[188:191], v1, s[44:47], s72 offen offset:1024 sc1
    s_sub_u32 s61, s61, 1
    s_cbranch_scc1 L_end
L_g84_near:
    s_waitcnt vmcnt(1)
    v_xor_b32 v184, s55, v184
    v_xor_b32 v185, s56, v185
    v_xor_b32 v186, s57, v186
    v_xor_b32 v187, s58, v187
    v_or3_b32 v238, v184, v185, v186
    s_waitcnt vmcnt(0)
    v_xor_b32 v188, s55, v188
    v_xor_b32 v190, s57, v190
    v_add_f32 v244, v184, v188
    v_add_f32 v246, v186, v190
    v_xor_b32 v189, s56, v189
    v_xor_b32 v191, s58, v191
    v_permlane32_swap_b32 v244, v246
    v_add_f32 v245, v185, v189
    v_add_f32 v247, v187, v191
    v_add_f32 v244, v244, v246
    v_or3_b32 v238, v238, v187, v188
    v_permlane32_swap_b32 v245, v247
    v_add_f32 v245, v245, v247
    v_or3_b32 v238, v238, v189, v190
    v_or_b32 v238, v238, v191
    v_permlane16_swap_b32 v244, v245
    v_add_f32 v244, v244, v245
    v_and_b32 v238, 0xff, v238
    v_cmp_ne_u32 vcc, 0, v238
    v_add_f32_dpp v244, v244, v244 row_ror:8
    s_cbranch_vccnz L_r83_near
    s_nop 0
    v_add_f32_dpp v244, v244, v244 row_ror:4
    v_cvt_pk_bf16_f32 v244, v244, v244
    v_and_b32 v244, s69, v244
    v_add_f32 v244, v244, v33
    v_cvt_pk_bf16_f32 v237, v244, v244
    s_add_u32 s72, s72, 131072
    v_and_b32 v33, s69, v237
    v_mov_b32 v239, s3
    buffer_store_dword v239, v11, s[44:47], s63 offen offset:0
L_s85_near:
    buffer_load_dword v236, v12, s[44:47], s63 offen offset:0 sc1
    s_sub_u32 s61, s61, 1
    s_cbranch_scc1 L_end
    s_waitcnt vmcnt(0)
    v_cmp_eq_u32 vcc, -1, v236
    s_cbranch_vccnz L_s85_near
    v_and_b32 v242, 1, v236
    v_cmp_ne_u32 vcc, 0, v242
    s_nop 0
    s_bcnt1_i32_b64 s66, vcc
    s_cmp_ge_u32 s66, 46
    s_cselect_b32 s72, 8192, 0
    s_add_u32 s72, s72, s74
    s_sub_u32 s72, s72, 131072
    s_add_u32 s67, s74, 131072
    buffer_store_dword v32, v9, s[44:47], s67 offen offset:0 sc1
    s_branch L_join15_near
L_u13_near:
    s_waitcnt lgkmcnt(0)
    ds_read_b32 v251, v22 offset:2944
    ds_read_b128 v[200:203], v19 offset:0
    ds_read_b128 v[204:207], v19 offset:64
    ds_read_b128 v[208:211], v19 offset:128
    ds_read_b128 v[212:215], v19 offset:192
    s_sub_u32 s61, s61, 1
    s_cbranch_scc1 L_end
    s_branch L_t12_near
L_u49_near:
    s_waitcnt lgkmcnt(0)
    ds_read_b32 v251, v22 offset:3200
    ds_read_b128 v[200:203], v19 offset:0
    ds_read_b128 v[204:207], v19 offset:64
    ds_read_b128 v[208:211], v19 offset:128
    ds_read_b128 v[212:215], v19 offset:192
    s_sub_u32 s61, s61, 1
    s_cbranch_scc1 L_end
    s_branch L_t48_near
L_u51_near:
    s_waitcnt lgkmcnt(0)
    ds_read_b32 v239, v22 offset:3264
    ds_read_b128 v[200:203], v24
    ds_read_b128 v[232:235], v28
    ds_read_b128 v[204:207], v25
    ds_read_b128 v[208:211], v26
    ds_read_b128 v[212:215], v27
    s_sub_u32 s61, s61, 1
    s_cbranch_scc1 L_end
    s_branch L_t50_near
L_u64_near:
    s_waitcnt lgkmcnt(0)
    ds_read_b32 v251, v22 offset:3328
    ds_read_b128 v[200:203], v19 offset:0
    ds_read_b128 v[204:207], v19 offset:64
    ds_read_b128 v[208:211], v19 offset:128
    ds_read_b128 v[212:215], v19 offset:192
    s_sub_u32 s61, s61, 1
    s_cbranch_scc1 L_end
    s_branch L_t63_near
L_body_far:
    ds_read_b128 v[200:203], v19 offset:0
    ds_read_b128 v[204:207], v19 offset:64
    ds_read_b128 v[208:211], v19 offset:128
    ds_read_b128 v[212:215], v19 offset:192
    v_mov_b32 v184, -1
    v_mov_b32 v185, -1
    v_lshlrev_b32 v250, 3, v0
    s_lshl_b32 s66, s49, 11
    s_add_u32 s66, s66, s63
    s_add_u32 s66, s66, 34816
    s_cmp_lt_u32 s49, 27
    s_cselect_b32 s66, s66, 1073741824
    buffer_store_dword v184, v6, s[44:47], s63 offen offset:0 sc1
    buffer_store_dwordx2 v[184:185], v250, s[44:47], s66 offen offset:0 sc1
    s_barrier
    s_add_u32 m0, s64, 86016
    s_add_u32 s65, s76, 32768
    buffer_load_dwordx4 v37, s[12:15], s65 offen offset:0 nt lds
    s_add_u32 m0, s64, 90112
    s_add_u32 s65, s76, 65536
    buffer_load_dwordx4 v37, s[12:15], s65 offen offset:0 nt lds
    s_add_u32 m0, s64, 94208
    s_add_u32 s65, s76, 98304
    buffer_load_dwordx4 v37, s[12:15], s65 offen offset:0 nt lds
    s_waitcnt lgkmcnt(3)
    v_mfma_f32_16x16x32_bf16 v[216:219], v[80:83], v[200:203], 0
    s_waitcnt lgkmcnt(2)
    v_mfma_f32_16x16x32_bf16 v[216:219], v[84:87], v[204:207], v[216:219]
    s_waitcnt lgkmcnt(1)
    v_mfma_f32_16x16x32_bf16 v[216:219], v[88:91], v[208:211], v[216:219]
    s_waitcnt lgkmcnt(0)
    v_mfma_f32_16x16x32_bf16 v[216:219], v[92:95], v[212:215], v[216:219]
    v_mfma_f32_16x16x32_bf16 v[220:223], v[96:99], v[200:203], 0
    v_mfma_f32_16x16x32_bf16 v[220:223], v[100:103], v[204:207], v[220:223]
    v_mfma_f32_16x16x32_bf16 v[220:223], v[104:107], v[208:211], v[220:223]
    v_mfma_f32_16x16x32_bf16 v[220:223], v[108:111], v[212:215], v[220:223]
    s_nop 3
    v_max3_f32 v236, v216, v217, v218
    v_mov_b32_dpp v216, v218 quad_perm:[0,1,2,3] row_mask:0xf bank_mask:0x2
    v_mov_b32_dpp v217, v219 quad_perm:[0,1,2,3] row_mask:0xf bank_mask:0x2
    v_max_f32 v236, v236, v219
    v_max3_f32 v236, v236, v220, v221
    v_max3_f32 v237, v236, v222, v223
    v_max3_f32 v236, v236, v222, v223
    v_mov_b32_dpp v216, v220 quad_perm:[0,1,2,3] row_mask:0xf bank_mask:0x4
    v_mov_b32_dpp v217, v221 quad_perm:[0,1,2,3] row_mask:0xf bank_mask:0x4
    v_permlane32_swap_b32 v236, v237
    v_max_f32 v236, v236, v237
    v_mov_b32 v237, v236
    v_mov_b32_dpp v216, v222 quad_perm:[0,1,2,3] row_mask:0xf bank_mask:0x8
    v_mov_b32_dpp v217, v223 quad_perm:[0,1,2,3] row_mask:0xf bank_mask:0x8
    v_permlane16_swap_b32 v236, v237
    v_max_f32 v236, v236, v237
    v_mul_f32 v236, v236, v36
    v_fma_f32 v216, v216, v36, -v236
    v_fma_f32 v217, v217, v36, -v236
    v_exp_f32 v216, v216
    v_exp_f32 v217, v217
    ds_write_b32 v21, v236
    v_cvt_pk_bf16_f32 v216, v216, v217
    ds_write_b32 v20, v216
    buffer_load_dword v51, off, s[16:19], s77 nt
    buffer_load_dword v51, off, s[32:35], s77 nt
    buffer_load_dword v51, off, s[36:39], s79 nt
    v_cmp_gt_u32 vcc, 8, v4
    v_mov_b32 v50, 1073741824
    v_not_b32 v224, s55
    v_not_b32 v225, s56
    v_not_b32 v226, s57
    v_not_b32 v227, s58
    v_cndmask_b32 v50, v50, v49, vcc
    s_add_u32 s67, s74, 131072
    buffer_store_dwordx4 v[224:227], v50, s[44:47], s67 offen sc1
    s_waitcnt vmcnt(7)
    s_waitcnt vmcnt(18)
    s_waitcnt lgkmcnt(0)
    s_barrier
    ds_read_b32 v239, v22
    ds_read_b128 v[200:203], v24
    ds_read_b128 v[232:235], v28
    ds_read_b128 v[204:207], v25
    ds_read_b128 v[208:211], v26
    ds_read_b128 v[212:215], v27
    s_waitcnt lgkmcnt(0)
    ds_read_b64_tr_b16 v[112:113], v30 offset:0
    ds_read_b64_tr_b16 v[114:115], v30 offset:4096
    ds_read_b64_tr_b16 v[128:129], v31 offset:0
    ds_read_b64_tr_b16 v[130:131], v31 offset:4096
    ds_read_b64_tr_b16 v[116:117], v30 offset:8192
    ds_read_b64_tr_b16 v[118:119], v30 offset:12288
    ds_read_b64_tr_b16 v[132:133], v31 offset:8192
    ds_read_b64_tr_b16 v[134:135], v31 offset:12288
    v_mfma_f32_16x16x32_bf16 v[224:227], v[60:63], v[232:235], 0
    v_max_f32_dpp v42, v239, v239 row_ror:8
    s_nop 1
    v_max_f32_dpp v42, v42, v42 row_ror:4
    v_sub_f32 v240, v239, v42
    v_exp_f32 v240, v240
    s_nop 1
    v_mul_f32 v44, v224, v240
    s_nop 1
    v_add_f32_dpp v44, v44, v44 row_ror:8
    s_nop 1
    v_add_f32_dpp v44, v44, v44 row_ror:4
    s_waitcnt lgkmcnt(4)
    v_mfma_f32_16x16x32_bf16 v[216:219], v[112:115], v[200:203], 0
    v_mfma_f32_16x16x32_bf16 v[220:223], v[128:131], v[200:203], 0
    s_waitcnt lgkmcnt(0)
    v_mfma_f32_16x16x32_bf16 v[216:219], v[116:119], v[204:207], v[216:219]
    v_mfma_f32_16x16x32_bf16 v[220:223], v[132:135], v[204:207], v[220:223]
    s_waitcnt vmcnt(7)
    s_waitcnt vmcnt(9)
    s_barrier
    ds_read_b64_tr_b16 v[120:121], v30 offset:16384
    ds_read_b64_tr_b16 v[122:123], v30 offset:20480
    ds_read_b64_tr_b16 v[136:137], v31 offset:16384
    ds_read_b64_tr_b16 v[138:139], v31 offset:20480
    ds_read_b64_tr_b16 v[124:125], v30 offset:24576
    ds_read_b64_tr_b16 v[126:127], v30 offset:28672
    ds_read_b64_tr_b16 v[140:141], v31 offset:24576
    ds_read_b64_tr_b16 v[142:143], v31 offset:28672
    s_waitcnt lgkmcnt(4)
    v_mfma_f32_16x16x32_bf16 v[216:219], v[120:123], v[208:211], v[216:219]
    v_mfma_f32_16x16x32_bf16 v[220:223], v[136:139], v[208:211], v[220:223]
    s_waitcnt lgkmcnt(0)
    v_mfma_f32_16x16x32_bf16 v[216:219], v[124:127], v[212:215], v[216:219]
    v_mfma_f32_16x16x32_bf16 v[220:223], v[140:143], v[212:215], v[220:223]
    s_nop 6
    v_pk_mul_f32 v[216:217], v[216:217], v[240:241] op_sel_hi:[1,0]
    v_pk_mul_f32 v[218:219], v[218:219], v[240:241] op_sel_hi:[1,0]
    v_pk_mul_f32 v[220:221], v[220:221], v[240:241] op_sel_hi:[1,0]
    v_pk_mul_f32 v[222:223], v[222:223], v[240:241] op_sel_hi:[1,0]
    v_add_f32_dpp v244, v216, v216 row_ror:8 row_mask:0xf bank_mask:0x3
    v_add_f32_dpp v245, v217, v217 row_ror:8 row_mask:0xf bank_mask:0x3
    v_add_f32_dpp v246, v218, v218 row_ror:8 row_mask:0xf bank_mask:0x3
    v_add_f32_dpp v247, v219, v219 row_ror:8 row_mask:0xf bank_mask:0x3
    v_add_f32_dpp v244, v220, v220 row_ror:8 row_mask:0xf bank_mask:0xc
    v_add_f32_dpp v245, v221, v221 row_ror:8 row_mask:0xf bank_mask:0xc
    v_add_f32_dpp v246, v222, v222 row_ror:8 row_mask:0xf bank_mask:0xc
    v_add_f32_dpp v247, v223, v223 row_ror:8 row_mask:0xf bank_mask:0xc
    v_add_f32_dpp v248, v244, v244 row_shl:4 row_mask:0xf bank_mask:0x5
    v_add_f32_dpp v249, v245, v245 row_shl:4 row_mask:0xf bank_mask:0x5
    s_nop 0
    v_add_f32_dpp v248, v246, v246 row_shr:4 row_mask:0xf bank_mask:0xa
    v_add_f32_dpp v249, v247, v247 row_shr:4 row_mask:0xf bank_mask:0xa
    v_cvt_pk_bf16_f32 v248, v248, v249
    v_min_u32 v248, s70, v248
    buffer_store_dword v248, v6, s[44:47], s63 offen offset:0 sc1
    s_barrier
    s_cmp_lg_u32 s52, 3
    s_cbranch_scc1 L_m1_far
    buffer_store_dwordx4 v[42:45], v7, s[44:47], s63 offen offset:0 sc1
L_m1_far:
    buffer_load_dwordx4 v[192:195], v8, s[44:47], s63 offen offset:0 sc1
    s_nop 7
    s_nop 7
    s_nop 7
    buffer_load_dwordx4 v[196:199], v8, s[44:47], s63 offen offset:0 sc1
    s_branch L_sg3_far
L_b6_far:
    buffer_load_dwordx4 v[184:187], v1, s[44:47], s75 offen offset:0 sc1
    buffer_load_dwordx4 v[188:191], v1, s[44:47], s75 offen offset:1024 sc1
    s_sub_u32 s61, s61, 1
    s_cbranch_scc1 L_end
    s_waitcnt vmcnt(0)
    s_branch L_a5_far
L_i11_far:
    buffer_load_dwordx4 v[184:187], v1, s[44:47], s75 offen offset:0 sc1
    buffer_load_dwordx4 v[188:191], v1, s[44:47], s75 offen offset:1024 sc1
    v_mov_b32 v236, v196
    v_mov_b32 v237, v198
    s_branch L_go4_far
L_s2_far:
    buffer_load_dwordx4 v[192:195], v8, s[44:47], s63 offen offset:0 sc1
    s_sub_u32 s61, s61, 1
    s_cbranch_scc1 L_end
    s_waitcnt vmcnt(1)
    v_xor_b32 v243, s54, v197
    v_bitop3_b32 v243, v243, v199, s54 bitop3:0xf6
    v_cmp_ne_u32 vcc, 0, v243
    s_cbranch_vccz L_i11_far
    buffer_load_dwordx4 v[196:199], v8, s[44:47], s63 offen offset:0 sc1
L_sg3_far:
    s_waitcnt vmcnt(1)
    v_xor_b32 v243, s54, v193
    v_bitop3_b32 v243, v243, v195, s54 bitop3:0xf6
    v_cmp_ne_u32 vcc, 0, v243
    s_cbranch_vccnz L_s2_far
    buffer_load_dwordx4 v[184:187], v1, s[44:47], s75 offen offset:0 sc1
    buffer_load_dwordx4 v[188:191], v1, s[44:47], s75 offen offset:1024 sc1
    v_mov_b32 v236, v192
    v_mov_b32 v237, v194
L_go4_far:
    s_barrier
    s_add_u32 m0, s64, 98304
    s_nop 0
    buffer_load_dwordx4 v38, s[16:19], s77 offen offset:0 nt lds
    s_add_u32 m0, s64, 102400
    s_nop 0
    buffer_load_dwordx4 v38, s[16:19], s78 offen offset:0 nt lds
    s_add_u32 m0, s64, 106496
    s_nop 0
    buffer_load_dwordx4 v38, s[32:35], s77 offen offset:0 nt lds
    ds_read_b64_tr_b16 v[144:145], v23 offset:0
    ds_read_b64_tr_b16 v[146:147], v23 offset:512
    ds_read_b64_tr_b16 v[148:149], v23 offset:4096
    ds_read_b64_tr_b16 v[150:151], v23 offset:4608
    ds_read_b64_tr_b16 v[152:153], v23 offset:8192
    ds_read_b64_tr_b16 v[154:155], v23 offset:8704
    ds_read_b64_tr_b16 v[156:157], v23 offset:12288
    ds_read_b64_tr_b16 v[158:159], v23 offset:12800
    v_max_f32_dpp v242, v236, v236 quad_perm:[1,0,3,2]
    s_nop 1
    v_max_f32_dpp v242, v242, v242 quad_perm:[2,3,0,1]
    s_nop 1
    v_max_f32_dpp v242, v242, v242 row_ror:4
    s_nop 1
    v_max_f32_dpp v242, v242, v242 row_ror:8
    v_mov_b32 v243, v242
    s_nop 1
    v_permlane16_swap_b32 v242, v243
    v_max_f32 v242, v242, v243
    v_sub_f32 v236, v236, v242
    v_exp_f32 v236, v236
    s_nop 0
    v_cvt_pk_bf16_f32 v236, v236, v236
    v_and_b32 v242, s69, v236
    v_mul_f32 v237, v237, v242
    v_and_b32_dpp v228, v236, v52 row_newbcast:0
    v_and_b32_dpp v229, v236, v53 row_newbcast:0
    v_add_f32_dpp v237, v237, v237 quad_perm:[1,0,3,2]
    v_and_b32_dpp v230, v236, v54 row_newbcast:0
    v_and_b32_dpp v231, v236, v55 row_newbcast:0
    v_add_f32_dpp v237, v237, v237 quad_perm:[2,3,0,1]
    v_and_b32_dpp v232, v236, v52 row_newbcast:1
    v_and_b32_dpp v233, v236, v53 row_newbcast:1
    v_add_f32_dpp v237, v237, v237 row_ror:4
    v_and_b32_dpp v234, v236, v54 row_newbcast:1
    v_and_b32_dpp v235, v236, v55 row_newbcast:1
    v_add_f32_dpp v237, v237, v237 row_ror:8
    v_mov_b32 v242, v237
    s_nop 1
    v_permlane16_swap_b32 v237, v242
    v_add_f32 v237, v237, v242
    v_rcp_f32 v237, v237
L_a5_far:
    s_waitcnt vmcnt(4)
    v_mfma_f32_16x16x32_bf16 v[216:219], v[228:231], v[184:187], 0
    v_max3_u32 v243, v184, v185, v186
    s_waitcnt vmcnt(3)
    v_mfma_f32_16x16x32_bf16 v[216:219], v[232:235], v[188:191], v[216:219]
    v_max3_u32 v243, v243, v187, v188
    v_max3_u32 v243, v243, v189, v190
    v_max_u32 v243, v243, v191
    v_cmp_eq_u32 vcc, -1, v243
    s_cbranch_vccnz L_b6_far
    s_nop 2
    v_cvt_pk_bf16_f32 v244, v216, v217
    v_cvt_pk_bf16_f32 v245, v218, v219
    ds_write_b64 v18, v[244:245]
    ds_write_b32 v21, v60 offset:2944
    s_barrier
    ds_read_b32 v251, v22 offset:2944
    ds_read_b128 v[200:203], v19 offset:0
    ds_read_b128 v[204:207], v19 offset:64
    ds_read_b128 v[208:211], v19 offset:128
    ds_read_b128 v[212:215], v19 offset:192
L_t12_far:
    s_waitcnt lgkmcnt(3)
    v_cmp_eq_u32 vcc, 0, v251
    v_mfma_f32_16x16x32_bf16 v[216:219], v[200:203], v[144:147], 0
    s_cbranch_vccnz L_u13_far
    s_waitcnt lgkmcnt(2)
    v_mfma_f32_16x16x32_bf16 v[216:219], v[204:207], v[148:151], v[216:219]
    s_waitcnt lgkmcnt(1)
    v_mfma_f32_16x16x32_bf16 v[216:219], v[208:211], v[152:155], v[216:219]
    s_waitcnt lgkmcnt(0)
    v_mfma_f32_16x16x32_bf16 v[216:219], v[212:215], v[156:159], v[216:219]
    s_nop 7
    v_pk_add_f32 v[244:245], v[216:217], v[218:219]
    v_add_f32 v244, v244, v245
    v_mul_f32 v244, v244, v237
    v_and_or_b32 v244, v244, s71, v32
    buffer_store_dword v244, v9, s[44:47], s74 offen offset:0 sc1
    s_add_u32 s74, s74, 131072
    s_add_u32 m0, s64, 110592
    s_nop 0
    buffer_load_dwordx4 v38, s[32:35], s78 offen offset:0 nt lds
    v_lshlrev_b32 v250, 3, v0
    s_lshl_b32 s66, s49, 11
    s_add_u32 s66, s66, s63
    s_add_u32 s66, s66, 34816
    s_cmp_lt_u32 s49, 27
    s_cselect_b32 s66, s66, 1073741824
    buffer_load_dwordx2 v[198:199], v250, s[44:47], s66 offen nt
    s_add_u32 s76, s75, 40960
    buffer_store_short v48, v5, s[44:47], s63 offen offset:2048 sc1
    s_cmp_eq_u32 s48, 0
    s_cbranch_scc1 L_g014_far
    s_add_u32 m0, s64, 114688
    s_add_u32 s65, s79, 0
    buffer_load_dwordx4 v37, s[36:39], s65 offen offset:0 nt lds
    s_add_u32 m0, s64, 118784
    s_add_u32 s65, s79, 32768
    buffer_load_dwordx4 v37, s[36:39], s65 offen offset:0 nt lds
    s_lshl_b32 s66, s53, 6
    s_add_u32 s66, s66, s74
    s_add_u32 s66, s66, 0
    s_add_u32 s67, s66, 8192
    s_mov_b32 s28, s54
    s_waitcnt lgkmcnt(0)
    s_load_dword s29, s[44:45], s67 glc
    s_load_dword s28, s[44:45], s66 glc
    s_waitcnt lgkmcnt(1)
    s_nop 3
    s_cmp_eq_u32 s28, s54
    s_cselect_b32 s3, 1, 0
    s_cselect_b32 s72, 8192, 0
    s_add_u32 s72, s72, s74
    s_sub_u32 s72, s72, 131072
    s_waitcnt vmcnt(4)
    buffer_load_dwordx4 v[184:187], v1, s[44:47], s72 offen offset:0 sc1
    buffer_load_dwordx4 v[188:191], v1, s[44:47], s72 offen offset:1024 sc1
    s_waitcnt vmcnt(6)
    s_barrier
    ds_read_b64_tr_b16 v[160:161], v23 offset:16384
    ds_read_b64_tr_b16 v[162:163], v23 offset:16896
    ds_read_b64_tr_b16 v[164:165], v23 offset:20480
    ds_read_b64_tr_b16 v[166:167], v23 offset:20992
    ds_read_b64_tr_b16 v[168:169], v23 offset:24576
    ds_read_b64_tr_b16 v[170:171], v23 offset:25088
    ds_read_b64_tr_b16 v[172:173], v23 offset:28672
    ds_read_b64_tr_b16 v[174:175], v23 offset:29184
    s_branch L_g17_far
L_r16_far:
    buffer_load_dwordx4 v[184:187], v1, s[44:47], s72 offen offset:0 sc1
    buffer_load_dwordx4 v[188:191], v1, s[44:47], s72 offen offset:1024 sc1
    s_sub_u32 s61, s61, 1
    s_cbranch_scc1 L_end
L_g17_far:
    s_waitcnt vmcnt(1)
    v_xor_b32 v184, s55, v184
    v_xor_b32 v185, s56, v185
    v_xor_b32 v186, s57, v186
    v_xor_b32 v187, s58, v187
    v_or3_b32 v238, v184, v185, v186
    s_waitcnt vmcnt(0)
    v_xor_b32 v188, s55, v188
    v_xor_b32 v190, s57, v190
    v_add_f32 v244, v184, v188
    v_add_f32 v246, v186, v190
    v_xor_b32 v189, s56, v189
    v_xor_b32 v191, s58, v191
    v_permlane32_swap_b32 v244, v246
    v_add_f32 v245, v185, v189
    v_add_f32 v247, v187, v191
    v_add_f32 v244, v244, v246
    v_or3_b32 v238, v238, v187, v188
    v_permlane32_swap_b32 v245, v247
    v_add_f32 v245, v245, v247
    v_or3_b32 v238, v238, v189, v190
    v_or_b32 v238, v238, v191
    v_permlane16_swap_b32 v244, v245
    v_add_f32 v244, v244, v245
    v_and_b32 v238, 0xff, v238
    v_cmp_ne_u32 vcc, 0, v238
    v_add_f32_dpp v244, v244, v244 row_ror:8
    s_cbranch_vccnz L_r16_far
    s_nop 0
    v_add_f32_dpp v244, v244, v244 row_ror:4
    v_cvt_pk_bf16_f32 v244, v244, v244
    v_and_b32 v244, s69, v244
    v_add_f32 v244, v244, v33
    v_cvt_pk_bf16_f32 v237, v244, v244
    ds_write_b16 v14, v237
    s_add_u32 s72, s72, 131072
    v_and_b32 v33, s69, v237
    v_and_b32 v239, s69, v237
    v_mul_f32 v240, v33, v33
    s_nop 1
    v_permlane32_swap_b32 v239, v240
    v_add_f32 v239, v239, v240
    v_mov_b32 v240, v239
    s_nop 1
    v_permlane16_swap_b32 v239, v240
    v_add_f32 v239, v239, v240
    s_nop 1
    v_add_f32_dpp v239, v239, v239 quad_perm:[1,0,3,2]
    s_nop 1
    v_add_f32_dpp v239, v239, v239 quad_perm:[2,3,0,1]
    v_and_or_b32 v239, v239, -4, s3
    buffer_store_dword v239, v11, s[44:47], s63 offen offset:0 sc1
    s_waitcnt lgkmcnt(0)
    s_barrier
    ds_read_b128 v[200:203], v15 offset:0
    ds_read_b128 v[204:207], v15 offset:64
L_t18_far:
    s_waitcnt lgkmcnt(1)
    v_mfma_f32_16x16x32_bf16 v[216:219], v[200:203], v[160:163], 0
    v_mfma_f32_16x16x32_bf16 v[220:223], v[200:203], v[168:171], 0
    s_waitcnt lgkmcnt(0)
    v_mfma_f32_16x16x32_bf16 v[216:219], v[204:207], v[164:167], v[216:219]
    v_mfma_f32_16x16x32_bf16 v[220:223], v[204:207], v[172:175], v[220:223]
    buffer_load_dword v192, v12, s[44:47], s63 offen offset:0 sc1
    s_nop 6
    buffer_store_dwordx4 v[218:221], v10, s[44:47], s76 offen offset:0 sc1
    s_nop 7
    buffer_load_dword v196, v12, s[44:47], s63 offen offset:0 sc1
    s_branch L_sg21_far
L_b24_far:
    buffer_load_dwordx4 v[184:187], v1, s[44:47], s76 offen offset:0 sc1
    buffer_load_dwordx4 v[188:191], v1, s[44:47], s76 offen offset:1024 sc1
    s_sub_u32 s61, s61, 1
    s_cbranch_scc1 L_end
    s_branch L_a23_far
L_i29_far:
    buffer_load_dwordx4 v[184:187], v1, s[44:47], s76 offen offset:0 sc1
    buffer_load_dwordx4 v[188:191], v1, s[44:47], s76 offen offset:1024 sc1
    v_and_b32 v236, -4, v196
    v_and_b32 v237, -4, v196
    s_branch L_go22_far
L_s20_far:
    buffer_load_dword v192, v12, s[44:47], s63 offen offset:0 sc1
    s_sub_u32 s61, s61, 1
    s_cbranch_scc1 L_end
    s_waitcnt vmcnt(1)
    v_cmp_eq_u32 vcc, -1, v196
    s_cbranch_vccz L_i29_far
    buffer_load_dword v196, v12, s[44:47], s63 offen offset:0 sc1
    s_waitcnt vmcnt(1)
L_sg21_far:
    s_waitcnt vmcnt(2)
    v_cmp_eq_u32 vcc, -1, v192
    s_cbranch_vccnz L_s20_far
    buffer_load_dwordx4 v[184:187], v1, s[44:47], s76 offen offset:0 sc1
    buffer_load_dwordx4 v[188:191], v1, s[44:47], s76 offen offset:1024 sc1
    v_and_b32 v236, -4, v192
    v_and_b32 v237, -4, v192
L_go22_far:
    ds_read_b64_tr_b16 v[176:177], v23 offset:32768
    ds_read_b64_tr_b16 v[178:179], v23 offset:33280
    ds_read_b64_tr_b16 v[180:181], v23 offset:36864
    ds_read_b64_tr_b16 v[182:183], v23 offset:37376
    v_permlane16_swap_b32 v236, v237
    v_add_f32 v236, v236, v237
    s_nop 1
    v_add_f32_dpp v236, v236, v236 row_ror:8
    s_nop 1
    v_add_f32_dpp v236, v236, v236 row_ror:4
    s_nop 1
    v_add_f32_dpp v236, v236, v236 quad_perm:[2,3,0,1]
    s_nop 1
    v_add_f32_dpp v236, v236, v236 quad_perm:[1,0,3,2]
    v_mul_f32 v236, 0x3b000000, v236
    v_mov_b32 v237, v236
    s_nop 1
    v_permlane32_swap_b32 v236, v237
    v_cvt_pk_bf16_f32 v34, v236, v236
    v_and_b32 v34, s69, v34
    v_fma_f32 v237, -v236, v236, v237
    v_max_f32 v237, 0, v237
    v_cvt_pk_bf16_f32 v237, v237, v237
    v_and_b32 v237, s69, v237
    v_add_f32 v237, 0x3727c5ac, v237
    v_cvt_pk_bf16_f32 v237, v237, v237
    v_and_b32 v237, s69, v237
    v_sqrt_f32 v237, v237
    s_nop 0
    v_cvt_pk_bf16_f32 v237, v237, v237
    v_and_b32 v237, s69, v237
    v_rcp_f32 v35, v237
    s_nop 0
    v_mul_f32 v241, 0xbfb8aa3b, v35
L_a23_far:
    s_waitcnt vmcnt(1)
    v_fma_f32 v244, -v34, v185, v184
    v_fma_f32 v245, -v34, v187, v186
    v_max3_u32 v238, v184, v185, v186
    s_waitcnt vmcnt(0)
    v_add_f32 v244, v244, v188
    v_add_f32 v245, v245, v190
    v_fma_f32 v244, -v34, v189, v244
    v_fma_f32 v245, -v34, v191, v245
    v_max3_u32 v238, v238, v187, v188
    v_max3_u32 v238, v238, v189, v190
    v_permlane32_swap_b32 v244, v245
    v_add_f32 v244, v244, v245
    v_mov_b32 v245, v244
    v_max_u32 v238, v238, v191
    v_cmp_eq_u32 vcc, -1, v238
    v_permlane16_swap_b32 v244, v245
    s_cbranch_vccnz L_b24_far
    v_add_f32 v244, v244, v245
    v_mul_f32 v246, v244, v241
    v_mul_f32 v244, v244, v35
    v_exp_f32 v246, v246
    v_mov_b32 v247, v244
    v_add_f32 v246, 1.0, v246
    v_rcp_f32 v246, v246
    v_permlane32_swap_b32 v244, v247
    v_mul_f32 v246, v246, v244
    v_mul_f32 v246, v246, v247
    v_cvt_pk_bf16_f32 v246, v246, v246
    ds_write_b16 v16, v246
    s_waitcnt lgkmcnt(0)
    s_barrier
    ds_read_b128 v[200:203], v17 offset:0
    ds_read_b128 v[204:207], v17 offset:64
    s_add_u32 s67, s63, 36864
    buffer_load_dwordx4 v[192:195], v1, s[44:47], s67 offen offset:0 sc1
L_t30_far:
    s_waitcnt lgkmcnt(1)
    v_mfma_f32_16x16x32_bf16 v[216:219], v[200:203], v[176:179], 0
    s_waitcnt lgkmcnt(0)
    v_mfma_f32_16x16x32_bf16 v[216:219], v[204:207], v[180:183], v[216:219]
    s_nop 7
    v_and_or_b32 v244, v216, s71, v32
    buffer_store_dword v244, v9, s[44:47], s74 offen offset:0 sc1
    s_add_u32 s74, s74, 131072
    v_cmp_gt_u32 vcc, 16, v4
    v_mov_b32 v50, 1073741824
    v_not_b32 v224, s55
    v_not_b32 v225, s56
    v_not_b32 v226, s57
    v_not_b32 v227, s58
    v_cndmask_b32 v50, v50, v49, vcc
    s_add_u32 s67, s74, 0
    buffer_store_dwordx4 v[224:227], v50, s[44:47], s67 offen sc1
    s_waitcnt vmcnt(2)
    v_and_b32 v236, 3, v192
    v_and_b32 v237, 3, v193
    v_and_b32 v238, 3, v194
    v_and_b32 v239, 3, v195
    v_cmp_eq_u32 vcc, 1, v236
    s_nop 0
    s_bcnt1_i32_b64 s67, vcc
    s_add_u32 s66, s67, 0
    v_cmp_eq_u32 vcc, 1, v237
    s_nop 0
    s_bcnt1_i32_b64 s67, vcc
    s_add_u32 s66, s67, s66
    v_cmp_eq_u32 vcc, 1, v238
    s_nop 0
    s_bcnt1_i32_b64 s67, vcc
    s_add_u32 s66, s67, s66
    v_cmp_eq_u32 vcc, 1, v239
    s_nop 0
    s_bcnt1_i32_b64 s67, vcc
    s_add_u32 s66, s67, s66
    s_cmp_ge_u32 s66, 48
    s_cselect_b32 s72, 8192, 0
    s_add_u32 s72, s72, s74
    s_sub_u32 s72, s72, 131072
    v_add_f32 v236, v185, v189
    v_add_f32 v237, v187, v191
    v_and_b32 v238, 7, v0
    v_and_b32 v239, 1, v3
    v_permlane32_swap_b32 v236, v237
    v_add_f32 v236, v236, v237
    v_mov_b32 v237, v236
    v_lshl_add_u32 v238, v238, 1, v239
    v_and_or_b32 v239, v0, 32, v238
    v_permlane16_swap_b32 v236, v237
    v_add_f32 v236, v236, v237
    v_lshlrev_b32 v239, 2, v239
    v_sub_u32 v238, v238, v2
    ds_bpermute_b32 v46, v239, v236
    v_lshl_add_u32 v16, v238, 1, v16
    v_lshrrev_b32 v10, 1, v10
L_join15_far:
    buffer_load_dwordx4 v[200:203], v1, s[44:47], s73 offen offset:2048 sc1
    buffer_load_dwordx4 v[204:207], v1, s[44:47], s73 offen offset:3072 sc1
    v_mov_b32 v228, -1
    v_mov_b32 v229, -1
    v_mov_b32 v230, -1
    v_mov_b32 v231, -1
    v_lshrrev_b32 v232, 2, v1
    s_lshl_b32 s62, s52, 5
    s_add_u32 s62, s62, s49
    s_lshl_b32 s62, s62, 8
    s_add_u32 s62, s62, s63
    buffer_store_dword v228, v232, s[44:47], s62 offen offset:0 sc1
    s_sub_u32 s78, s52, s50
    s_lshl_b32 s78, s78, 8
    s_add_u32 s78, s78, s63
    s_waitcnt vmcnt(0)
    buffer_load_dwordx4 v[184:187], v1, s[44:47], s72 offen offset:0 sc1
    buffer_load_dwordx4 v[188:191], v1, s[44:47], s72 offen offset:1024 sc1
    s_branch L_g33_far
L_r32_far:
    buffer_load_dwordx4 v[200:203], v1, s[44:47], s73 offen offset:2048 sc1
    buffer_load_dwordx4 v[204:207], v1, s[44:47], s73 offen offset:3072 sc1
    s_waitcnt vmcnt(0)
    s_sub_u32 s61, s61, 1
    s_cbranch_scc1 L_end
L_g33_far:
    s_waitcnt vmcnt(3)
    v_mfma_f32_16x16x32_bf16 v[216:219], v[56:59], v[200:203], 0
    v_max3_u32 v239, v200, v201, v202
    s_waitcnt vmcnt(2)
    v_mfma_f32_16x16x32_bf16 v[216:219], v[56:59], v[204:207], v[216:219]
    v_max3_u32 v239, v239, v203, v204
    v_max3_u32 v239, v239, v205, v206
    v_max_u32 v239, v239, v207
    v_cmp_eq_u32 vcc, -1, v239
    s_cbranch_vccnz L_r32_far
    s_nop 2
    v_mov_b32 v48, v216
    v_mov_b32 v49, v217
    v_mov_b32 v50, v218
    v_mov_b32 v51, v219
    s_branch L_g35_far
L_r34_far:
    buffer_load_dwordx4 v[184:187], v1, s[44:47], s72 offen offset:0 sc1
    buffer_load_dwordx4 v[188:191], v1, s[44:47], s72 offen offset:1024 sc1
    s_sub_u32 s61, s61, 1
    s_cbranch_scc1 L_end
L_g35_far:
    s_waitcnt vmcnt(1)
    v_xor_b32 v184, s55, v184
    v_xor_b32 v185, s56, v185
    v_xor_b32 v186, s57, v186
    v_xor_b32 v187, s58, v187
    v_or3_b32 v238, v184, v185, v186
    s_waitcnt vmcnt(0)
    v_xor_b32 v188, s55, v188
    v_xor_b32 v190, s57, v190
    v_add_f32 v244, v184, v188
    v_add_f32 v246, v186, v190
    v_xor_b32 v189, s56, v189
    v_xor_b32 v191, s58, v191
    v_permlane32_swap_b32 v244, v246
    v_add_f32 v245, v185, v189
    v_add_f32 v247, v187, v191
    v_add_f32 v244, v244, v246
    v_or3_b32 v238, v238, v187, v188
    v_permlane32_swap_b32 v245, v247
    v_add_f32 v245, v245, v247
    v_or3_b32 v238, v238, v189, v190
    v_or_b32 v238, v238, v191
    v_permlane16_swap_b32 v244, v245
    v_add_f32 v244, v244, v245
    v_and_b32 v238, 0xff, v238
    v_cmp_ne_u32 vcc, 0, v238
    v_add_f32_dpp v244, v244, v244 row_ror:8
    s_cbranch_vccnz L_r34_far
    s_nop 0
    v_add_f32_dpp v244, v244, v244 row_ror:4
    v_cvt_pk_bf16_f32 v244, v244, v244
    v_and_b32 v244, s69, v244
    v_add_f32 v244, v244, v33
    v_cvt_pk_bf16_f32 v237, v244, v244
    ds_write_b16 v14, v237
    s_add_u32 s72, s72, 131072
    v_and_b32 v33, s69, v237
    v_and_b32 v239, s69, v237
    v_mul_f32 v240, v33, v33
    s_nop 1
    v_permlane32_swap_b32 v239, v240
    v_add_f32 v239, v239, v240
    v_mov_b32 v240, v239
    s_nop 1
    v_permlane16_swap_b32 v239, v240
    v_add_f32 v239, v239, v240
    s_nop 1
    v_add_f32_dpp v239, v239, v239 quad_perm:[1,0,3,2]
    s_nop 1
    v_add_f32_dpp v239, v239, v239 quad_perm:[2,3,0,1]
    v_and_or_b32 v239, v239, -4, s3
    buffer_store_dword v239, v11, s[44:47], s63 offen offset:2048 sc1
    s_waitcnt lgkmcnt(0)
    s_barrier
    ds_read_b128 v[200:203], v15 offset:0
    ds_read_b128 v[204:207], v15 offset:64
L_t36_far:
    s_waitcnt lgkmcnt(1)
    v_mfma_f32_16x16x32_bf16 v[216:219], v[200:203], v[64:67], 0
    v_mfma_f32_16x16x32_bf16 v[220:223], v[200:203], v[72:75], 0
    s_waitcnt lgkmcnt(0)
    v_mfma_f32_16x16x32_bf16 v[216:219], v[204:207], v[68:71], v[216:219]
    v_mfma_f32_16x16x32_bf16 v[220:223], v[204:207], v[76:79], v[220:223]
    buffer_load_dword v192, v12, s[44:47], s78 offen offset:2048 sc1
    s_nop 6
    v_cvt_pk_bf16_f32 v244, v216, v220
    v_lshrrev_b32 v244, v39, v244
    v_min_u16 v244, v244, v40
    buffer_store_short v244, v5, s[44:47], s63 offen offset:0 sc1
    s_nop 7
    buffer_load_dword v196, v12, s[44:47], s78 offen offset:2048 sc1
    s_branch L_sg39_far
L_b42_far:
    buffer_load_dwordx4 v[184:187], v1, s[44:47], s73 offen offset:0 sc1
    buffer_load_dwordx4 v[188:191], v1, s[44:47], s73 offen offset:1024 sc1
    s_sub_u32 s61, s61, 1
    s_cbranch_scc1 L_end
    s_branch L_a41_far
L_i47_far:
    buffer_load_dwordx4 v[184:187], v1, s[44:47], s73 offen offset:0 sc1
    buffer_load_dwordx4 v[188:191], v1, s[44:47], s73 offen offset:1024 sc1
    v_and_b32 v236, -4, v196
    v_and_b32 v237, -4, v196
    s_branch L_go40_far
L_s38_far:
    buffer_load_dword v192, v12, s[44:47], s78 offen offset:2048 sc1
    s_sub_u32 s61, s61, 1
    s_cbranch_scc1 L_end
    s_waitcnt vmcnt(1)
    v_cmp_eq_u32 vcc, -1, v196
    s_cbranch_vccz L_i47_far
    buffer_load_dword v196, v12, s[44:47], s78 offen offset:2048 sc1
    s_waitcnt vmcnt(1)
L_sg39_far:
    s_waitcnt vmcnt(2)
    v_cmp_eq_u32 vcc, -1, v192
    s_cbranch_vccnz L_s38_far
    buffer_load_dwordx4 v[184:187], v1, s[44:47], s73 offen offset:0 sc1
    buffer_load_dwordx4 v[188:191], v1, s[44:47], s73 offen offset:1024 sc1
    v_and_b32 v236, -4, v192
    v_and_b32 v237, -4, v192
L_go40_far:
    s_nop 1
    v_permlane16_swap_b32 v236, v237
    v_add_f32 v236, v236, v237
    s_nop 1
    v_add_f32_dpp v236, v236, v236 row_ror:8
    s_nop 1
    v_add_f32_dpp v236, v236, v236 row_ror:4
    s_nop 1
    v_add_f32_dpp v236, v236, v236 quad_perm:[2,3,0,1]
    s_nop 1
    v_add_f32_dpp v236, v236, v236 quad_perm:[1,0,3,2]
    v_mul_f32 v236, 0x3b000000, v236
    v_mov_b32 v237, v236
    s_nop 1
    v_permlane32_swap_b32 v236, v237
    v_cvt_pk_bf16_f32 v34, v236, v236
    v_and_b32 v34, s69, v34
    v_fma_f32 v237, -v236, v236, v237
    v_max_f32 v237, 0, v237
    v_cvt_pk_bf16_f32 v237, v237, v237
    v_and_b32 v237, s69, v237
    v_add_f32 v237, 0x3727c5ac, v237
    v_cvt_pk_bf16_f32 v237, v237, v237
    v_and_b32 v237, s69, v237
    v_sqrt_f32 v237, v237
    s_nop 0
    v_cvt_pk_bf16_f32 v237, v237, v237
    v_and_b32 v237, s69, v237
    v_rcp_f32 v35, v237
    v_mul_f32_e64 v224, -v34, v48
    v_mul_f32_e64 v225, -v34, v49
    v_mul_f32_e64 v226, -v34, v50
    v_mul_f32_e64 v227, -v34, v51
    v_mul_f32 v36, v36, v35
L_a41_far:
    s_waitcnt vmcnt(1)
    v_mfma_f32_16x16x32_bf16 v[216:219], v[56:59], v[184:187], v[224:227]
    v_max3_u32 v238, v184, v185, v186
    s_waitcnt vmcnt(0)
    v_mfma_f32_16x16x32_bf16 v[216:219], v[56:59], v[188:191], v[216:219]
    v_max3_u32 v238, v238, v187, v188
    v_max3_u32 v238, v238, v189, v190
    v_max_u32 v238, v238, v191
    v_cmp_eq_u32 vcc, -1, v238
    s_cbranch_vccnz L_b42_far
    s_nop 2
    v_cvt_pk_bf16_f32 v244, v216, v217
    v_cvt_pk_bf16_f32 v245, v218, v219
    ds_write_b64 v18, v[244:245]
    ds_write_b32 v21, v60 offset:3200
    s_barrier
    ds_read_b32 v251, v22 offset:3200
    ds_read_b128 v[200:203], v19 offset:0
    ds_read_b128 v[204:207], v19 offset:64
    ds_read_b128 v[208:211], v19 offset:128
    ds_read_b128 v[212:215], v19 offset:192
L_t48_far:
    s_waitcnt lgkmcnt(3)
    v_cmp_eq_u32 vcc, 0, v251
    v_mfma_f32_16x16x32_bf16 v[216:219], v[80:83], v[200:203], 0
    s_cbranch_vccnz L_u49_far
    s_waitcnt lgkmcnt(2)
    v_mfma_f32_16x16x32_bf16 v[216:219], v[84:87], v[204:207], v[216:219]
    s_waitcnt lgkmcnt(1)
    v_mfma_f32_16x16x32_bf16 v[216:219], v[88:91], v[208:211], v[216:219]
    s_waitcnt lgkmcnt(0)
    v_mfma_f32_16x16x32_bf16 v[216:219], v[92:95], v[212:215], v[216:219]
    v_mfma_f32_16x16x32_bf16 v[220:223], v[96:99], v[200:203], 0
    v_mfma_f32_16x16x32_bf16 v[220:223], v[100:103], v[204:207], v[220:223]
    v_mfma_f32_16x16x32_bf16 v[220:223], v[104:107], v[208:211], v[220:223]
    v_mfma_f32_16x16x32_bf16 v[220:223], v[108:111], v[212:215], v[220:223]
    buffer_store_dwordx2 v[228:229], v10, s[44:47], s76 offen offset:0 sc1
    s_nop 2
    v_max3_f32 v236, v216, v217, v218
    v_mov_b32_dpp v216, v218 quad_perm:[0,1,2,3] row_mask:0xf bank_mask:0x2
    v_mov_b32_dpp v217, v219 quad_perm:[0,1,2,3] row_mask:0xf bank_mask:0x2
    v_max_f32 v236, v236, v219
    v_max3_f32 v236, v236, v220, v221
    v_max3_f32 v237, v236, v222, v223
    v_max3_f32 v236, v236, v222, v223
    v_mov_b32_dpp v216, v220 quad_perm:[0,1,2,3] row_mask:0xf bank_mask:0x4
    v_mov_b32_dpp v217, v221 quad_perm:[0,1,2,3] row_mask:0xf bank_mask:0x4
    v_permlane32_swap_b32 v236, v237
    v_max_f32 v236, v236, v237
    v_mov_b32 v237, v236
    v_mov_b32_dpp v216, v222 quad_perm:[0,1,2,3] row_mask:0xf bank_mask:0x8
    v_mov_b32_dpp v217, v223 quad_perm:[0,1,2,3] row_mask:0xf bank_mask:0x8
    v_permlane16_swap_b32 v236, v237
    v_max_f32 v236, v236, v237
    v_mul_f32 v236, v236, v36
    v_fma_f32 v216, v216, v36, -v236
    v_fma_f32 v217, v217, v36, -v236
    v_exp_f32 v216, v216
    v_exp_f32 v217, v217
    v_and_or_b32 v236, v236, -4, 1
    v_cvt_pk_bf16_f32 v216, v216, v217
    ds_write_b32 v20, v216
    ds_write_b32 v21, v236 offset:3264
    s_barrier
    ds_read_b32 v239, v22 offset:3264
    ds_read_b128 v[200:203], v24
    ds_read_b128 v[232:235], v28
    ds_read_b128 v[204:207], v25
    ds_read_b128 v[208:211], v26
    ds_read_b128 v[212:215], v27
L_t50_far:
    s_waitcnt lgkmcnt(4)
    v_cmp_eq_u32 vcc, 0, v239
    v_mfma_f32_16x16x32_bf16 v[216:219], v[112:115], v[200:203], 0
    s_cbranch_vccnz L_u51_far
    v_mfma_f32_16x16x32_bf16 v[220:223], v[128:131], v[200:203], 0
    s_waitcnt lgkmcnt(3)
    v_mfma_f32_16x16x32_bf16 v[224:227], v[60:63], v[232:235], 0
    s_waitcnt lgkmcnt(2)
    v_mfma_f32_16x16x32_bf16 v[216:219], v[116:119], v[204:207], v[216:219]
    v_mfma_f32_16x16x32_bf16 v[220:223], v[132:135], v[204:207], v[220:223]
    s_waitcnt lgkmcnt(1)
    v_mfma_f32_16x16x32_bf16 v[216:219], v[120:123], v[208:211], v[216:219]
    v_mfma_f32_16x16x32_bf16 v[220:223], v[136:139], v[208:211], v[220:223]
    s_waitcnt vmcnt(0) lgkmcnt(0)
    v_mfma_f32_16x16x32_bf16 v[216:219], v[124:127], v[212:215], v[216:219]
    v_max_f32_dpp v42, v239, v239 row_ror:8
    v_mfma_f32_16x16x32_bf16 v[220:223], v[140:143], v[212:215], v[220:223]
    s_nop 0
    v_max_f32_dpp v42, v42, v42 row_ror:4
    v_sub_f32 v240, v239, v42
    v_exp_f32 v240, v240
    s_nop 0
    v_mul_f32 v44, v224, v240
    s_nop 1
    v_add_f32_dpp v44, v44, v44 row_ror:8
    v_pk_mul_f32 v[216:217], v[216:217], v[240:241] op_sel_hi:[1,0]
    v_pk_mul_f32 v[218:219], v[218:219], v[240:241] op_sel_hi:[1,0]
    v_pk_mul_f32 v[220:221], v[220:221], v[240:241] op_sel_hi:[1,0]
    v_pk_mul_f32 v[222:223], v[222:223], v[240:241] op_sel_hi:[1,0]
    v_add_f32_dpp v44, v44, v44 row_ror:4
    buffer_store_dwordx4 v[42:45], v7, s[44:47], s63 offen offset:2048 sc1
    v_add_f32_dpp v244, v216, v216 row_ror:8 row_mask:0xf bank_mask:0x3
    v_add_f32_dpp v245, v217, v217 row_ror:8 row_mask:0xf bank_mask:0x3
    v_add_f32_dpp v246, v218, v218 row_ror:8 row_mask:0xf bank_mask:0x3
    v_add_f32_dpp v247, v219, v219 row_ror:8 row_mask:0xf bank_mask:0x3
    v_add_f32_dpp v244, v220, v220 row_ror:8 row_mask:0xf bank_mask:0xc
    v_add_f32_dpp v245, v221, v221 row_ror:8 row_mask:0xf bank_mask:0xc
    v_add_f32_dpp v246, v222, v222 row_ror:8 row_mask:0xf bank_mask:0xc
    v_add_f32_dpp v247, v223, v223 row_ror:8 row_mask:0xf bank_mask:0xc
    v_add_f32_dpp v248, v244, v244 row_shl:4 row_mask:0xf bank_mask:0x5
    v_add_f32_dpp v249, v245, v245 row_shl:4 row_mask:0xf bank_mask:0x5
    s_nop 0
    v_add_f32_dpp v248, v246, v246 row_shr:4 row_mask:0xf bank_mask:0xa
    v_add_f32_dpp v249, v247, v247 row_shr:4 row_mask:0xf bank_mask:0xa
    v_cvt_pk_bf16_f32 v248, v248, v249
    v_min_u32 v248, s70, v248
    buffer_store_dword v248, v6, s[44:47], s63 offen offset:0 sc1
    buffer_load_dwordx4 v[192:195], v8, s[44:47], s63 offen offset:2048 sc1
    s_nop 7
    s_nop 7
    s_nop 7
    buffer_load_dwordx4 v[196:199], v8, s[44:47], s63 offen offset:2048 sc1
    s_branch L_sg54_far
L_b57_far:
    buffer_load_dwordx4 v[184:187], v1, s[44:47], s75 offen offset:0 sc1
    buffer_load_dwordx4 v[188:191], v1, s[44:47], s75 offen offset:1024 sc1
    s_sub_u32 s61, s61, 1
    s_cbranch_scc1 L_end
    s_branch L_a56_far
L_i62_far:
    buffer_load_dwordx4 v[184:187], v1, s[44:47], s75 offen offset:0 sc1
    buffer_load_dwordx4 v[188:191], v1, s[44:47], s75 offen offset:1024 sc1
    v_mov_b32 v236, v196
    v_mov_b32 v237, v198
    s_branch L_go55_far
L_s53_far:
    buffer_load_dwordx4 v[192:195], v8, s[44:47], s63 offen offset:2048 sc1
    s_sub_u32 s61, s61, 1
    s_cbranch_scc1 L_end
    s_waitcnt vmcnt(1)
    v_xor_b32 v243, s54, v197
    v_bitop3_b32 v243, v243, v199, s54 bitop3:0xf6
    v_cmp_ne_u32 vcc, 0, v243
    s_cbranch_vccz L_i62_far
    buffer_load_dwordx4 v[196:199], v8, s[44:47], s63 offen offset:2048 sc1
L_sg54_far:
    s_waitcnt vmcnt(1)
    v_xor_b32 v243, s54, v193
    v_bitop3_b32 v243, v243, v195, s54 bitop3:0xf6
    v_cmp_ne_u32 vcc, 0, v243
    s_cbranch_vccnz L_s53_far
    buffer_load_dwordx4 v[184:187], v1, s[44:47], s75 offen offset:0 sc1
    buffer_load_dwordx4 v[188:191], v1, s[44:47], s75 offen offset:1024 sc1
    v_mov_b32 v236, v192
    v_mov_b32 v237, v194
L_go55_far:
    s_nop 0
    v_max_f32_dpp v242, v236, v236 quad_perm:[1,0,3,2]
    s_nop 1
    v_max_f32_dpp v242, v242, v242 quad_perm:[2,3,0,1]
    s_nop 1
    v_max_f32_dpp v242, v242, v242 row_ror:4
    s_nop 1
    v_max_f32_dpp v242, v242, v242 row_ror:8
    v_mov_b32 v243, v242
    s_nop 1
    v_permlane16_swap_b32 v242, v243
    v_max_f32 v242, v242, v243
    v_sub_f32 v236, v236, v242
    v_exp_f32 v236, v236
    s_nop 0
    v_cvt_pk_bf16_f32 v236, v236, v236
    v_and_b32 v242, s69, v236
    v_mul_f32 v237, v237, v242
    v_and_b32_dpp v228, v236, v52 row_newbcast:0
    v_and_b32_dpp v229, v236, v53 row_newbcast:0
    v_add_f32_dpp v237, v237, v237 quad_perm:[1,0,3,2]
    v_and_b32_dpp v230, v236, v54 row_newbcast:0
    v_and_b32_dpp v231, v236, v55 row_newbcast:0
    v_add_f32_dpp v237, v237, v237 quad_perm:[2,3,0,1]
    v_and_b32_dpp v232, v236, v52 row_newbcast:1
    v_and_b32_dpp v233, v236, v53 row_newbcast:1
    v_add_f32_dpp v237, v237, v237 row_ror:4
    v_and_b32_dpp v234, v236, v54 row_newbcast:1
    v_and_b32_dpp v235, v236, v55 row_newbcast:1
    v_add_f32_dpp v237, v237, v237 row_ror:8
    v_mov_b32 v242, v237
    s_nop 1
    v_permlane16_swap_b32 v237, v242
    v_add_f32 v237, v237, v242
    v_rcp_f32 v237, v237
L_a56_far:
    s_waitcnt vmcnt(1)
    v_mfma_f32_16x16x32_bf16 v[216:219], v[228:231], v[184:187], 0
    v_max3_u32 v243, v184, v185, v186
    s_waitcnt vmcnt(0)
    v_mfma_f32_16x16x32_bf16 v[216:219], v[232:235], v[188:191], v[216:219]
    v_max3_u32 v243, v243, v187, v188
    v_max3_u32 v243, v243, v189, v190
    v_max_u32 v243, v243, v191
    v_cmp_eq_u32 vcc, -1, v243
    s_cbranch_vccnz L_b57_far
    s_nop 2
    v_cvt_pk_bf16_f32 v244, v216, v217
    v_cvt_pk_bf16_f32 v245, v218, v219
    ds_write_b64 v18, v[244:245]
    ds_write_b32 v21, v60 offset:3328
    s_barrier
    ds_read_b32 v251, v22 offset:3328
    ds_read_b128 v[200:203], v19 offset:0
    ds_read_b128 v[204:207], v19 offset:64
    ds_read_b128 v[208:211], v19 offset:128
    ds_read_b128 v[212:215], v19 offset:192
L_t63_far:
    s_waitcnt lgkmcnt(3)
    v_cmp_eq_u32 vcc, 0, v251
    v_mfma_f32_16x16x32_bf16 v[216:219], v[200:203], v[144:147], 0
    s_cbranch_vccnz L_u64_far
    s_waitcnt lgkmcnt(2)
    v_mfma_f32_16x16x32_bf16 v[216:219], v[204:207], v[148:151], v[216:219]
    s_waitcnt lgkmcnt(1)
    v_mfma_f32_16x16x32_bf16 v[216:219], v[208:211], v[152:155], v[216:219]
    s_waitcnt lgkmcnt(0)
    v_mfma_f32_16x16x32_bf16 v[216:219], v[212:215], v[156:159], v[216:219]
    s_nop 7
    v_pk_add_f32 v[244:245], v[216:217], v[218:219]
    v_add_f32 v244, v244, v245
    v_mul_f32 v244, v244, v237
    v_and_or_b32 v244, v244, s71, v32
    buffer_store_dword v244, v9, s[44:47], s74 offen offset:0 sc1
    s_add_u32 s74, s74, 131072
    s_cmp_eq_u32 s48, 0
    s_cbranch_scc1 L_tag_far
    s_waitcnt vmcnt(0)
    buffer_load_dwordx4 v[184:187], v1, s[44:47], s72 offen offset:0 sc1
    buffer_load_dwordx4 v[188:191], v1, s[44:47], s72 offen offset:1024 sc1
    s_branch L_g66_far
L_r65_far:
    buffer_load_dwordx4 v[184:187], v1, s[44:47], s72 offen offset:0 sc1
    buffer_load_dwordx4 v[188:191], v1, s[44:47], s72 offen offset:1024 sc1
    s_sub_u32 s61, s61, 1
    s_cbranch_scc1 L_end
L_g66_far:
    s_waitcnt vmcnt(1)
    v_xor_b32 v184, s55, v184
    v_xor_b32 v185, s56, v185
    v_xor_b32 v186, s57, v186
    v_xor_b32 v187, s58, v187
    v_or3_b32 v238, v184, v185, v186
    s_waitcnt vmcnt(0)
    v_xor_b32 v188, s55, v188
    v_xor_b32 v190, s57, v190
    v_add_f32 v244, v184, v188
    v_add_f32 v246, v186, v190
    v_xor_b32 v189, s56, v189
    v_xor_b32 v191, s58, v191
    v_permlane32_swap_b32 v244, v246
    v_add_f32 v245, v185, v189
    v_add_f32 v247, v187, v191
    v_add_f32 v244, v244, v246
    v_or3_b32 v238, v238, v187, v188
    v_permlane32_swap_b32 v245, v247
    v_add_f32 v245, v245, v247
    v_or3_b32 v238, v238, v189, v190
    v_or_b32 v238, v238, v191
    v_permlane16_swap_b32 v244, v245
    v_add_f32 v244, v244, v245
    v_and_b32 v238, 0xff, v238
    v_cmp_ne_u32 vcc, 0, v238
    v_add_f32_dpp v244, v244, v244 row_ror:8
    s_cbranch_vccnz L_r65_far
    s_nop 0
    v_add_f32_dpp v244, v244, v244 row_ror:4
    v_cvt_pk_bf16_f32 v244, v244, v244
    v_and_b32 v244, s69, v244
    v_add_f32 v244, v244, v33
    v_cvt_pk_bf16_f32 v237, v244, v244
    ds_write_b16 v14, v237
    s_add_u32 s72, s72, 131072
    v_and_b32 v33, s69, v237
    v_and_b32 v239, s69, v237
    v_mul_f32 v240, v33, v33
    s_nop 1
    v_permlane32_swap_b32 v239, v240
    v_add_f32 v239, v239, v240
    v_mov_b32 v240, v239
    s_nop 1
    v_permlane16_swap_b32 v239, v240
    v_add_f32 v239, v239, v240
    s_nop 1
    v_add_f32_dpp v239, v239, v239 quad_perm:[1,0,3,2]
    s_nop 1
    v_add_f32_dpp v239, v239, v239 quad_perm:[2,3,0,1]
    v_and_or_b32 v239, v239, -4, s3
    buffer_store_dword v239, v11, s[44:47], s63 offen offset:1024 sc1
    s_waitcnt lgkmcnt(0)
    s_barrier
    ds_read_b128 v[200:203], v15 offset:0
    ds_read_b128 v[204:207], v15 offset:64
L_t67_far:
    s_waitcnt lgkmcnt(1)
    v_mfma_f32_16x16x32_bf16 v[216:219], v[200:203], v[160:163], 0
    v_mfma_f32_16x16x32_bf16 v[220:223], v[200:203], v[168:171], 0
    s_waitcnt lgkmcnt(0)
    v_mfma_f32_16x16x32_bf16 v[216:219], v[204:207], v[164:167], v[216:219]
    v_mfma_f32_16x16x32_bf16 v[220:223], v[204:207], v[172:175], v[220:223]
    buffer_load_dword v192, v12, s[44:47], s63 offen offset:1024 sc1
    s_nop 6
    v_mov_b32 v217, v220
    buffer_store_dwordx2 v[216:217], v10, s[44:47], s76 offen offset:0 sc1
    s_nop 7
    buffer_load_dword v196, v12, s[44:47], s63 offen offset:1024 sc1
    s_branch L_sg70_far
L_b73_far:
    buffer_load_dwordx4 v[184:187], v1, s[44:47], s76 offen offset:0 sc1
    s_sub_u32 s61, s61, 1
    s_cbranch_scc1 L_end
    s_branch L_a72_far
L_i78_far:
    buffer_load_dwordx4 v[184:187], v1, s[44:47], s76 offen offset:0 sc1
    v_and_b32 v236, -4, v196
    v_and_b32 v237, -4, v196
    s_branch L_go71_far
L_s69_far:
    buffer_load_dword v192, v12, s[44:47], s63 offen offset:1024 sc1
    s_sub_u32 s61, s61, 1
    s_cbranch_scc1 L_end
    s_waitcnt vmcnt(1)
    v_cmp_eq_u32 vcc, -1, v196
    s_cbranch_vccz L_i78_far
    buffer_load_dword v196, v12, s[44:47], s63 offen offset:1024 sc1
    s_waitcnt vmcnt(1)
L_sg70_far:
    s_waitcnt vmcnt(2)
    v_cmp_eq_u32 vcc, -1, v192
    s_cbranch_vccnz L_s69_far
    buffer_load_dwordx4 v[184:187], v1, s[44:47], s76 offen offset:0 sc1
    v_and_b32 v236, -4, v192
    v_and_b32 v237, -4, v192
L_go71_far:
    s_nop 1
    v_permlane16_swap_b32 v236, v237
    v_add_f32 v236, v236, v237
    s_nop 1
    v_add_f32_dpp v236, v236, v236 row_ror:8
    s_nop 1
    v_add_f32_dpp v236, v236, v236 row_ror:4
    s_nop 1
    v_add_f32_dpp v236, v236, v236 quad_perm:[2,3,0,1]
    s_nop 1
    v_add_f32_dpp v236, v236, v236 quad_perm:[1,0,3,2]
    v_mul_f32 v236, 0x3b000000, v236
    v_mov_b32 v237, v236
    s_nop 1
    v_permlane32_swap_b32 v236, v237
    v_cvt_pk_bf16_f32 v34, v236, v236
    v_and_b32 v34, s69, v34
    v_fma_f32 v237, -v236, v236, v237
    v_max_f32 v237, 0, v237
    v_cvt_pk_bf16_f32 v237, v237, v237
    v_and_b32 v237, s69, v237
    v_add_f32 v237, 0x3727c5ac, v237
    v_cvt_pk_bf16_f32 v237, v237, v237
    v_and_b32 v237, s69, v237
    v_sqrt_f32 v237, v237
    s_nop 0
    v_cvt_pk_bf16_f32 v237, v237, v237
    v_and_b32 v237, s69, v237
    v_rcp_f32 v35, v237
    v_mul_f32_e64 v243, -v34, v46
    v_mul_f32 v241, 0xbfb8aa3b, v35
    v_mul_f32 v242, v243, v35
    v_mul_f32 v243, v243, v241
L_a72_far:
    s_waitcnt vmcnt(0)
    v_permlane32_swap_b32 v184, v185
    v_permlane32_swap_b32 v186, v187
    v_add_f32 v244, v184, v185
    v_add_f32 v245, v186, v187
    v_max3_u32 v238, v184, v185, v186
    v_max_u32 v238, v238, v187
    v_permlane16_swap_b32 v244, v245
    v_add_f32 v244, v244, v245
    v_cmp_eq_u32 vcc, -1, v238
    s_cbranch_vccnz L_b73_far
    v_add_f32_dpp v244, v244, v244 row_ror:8
    v_fma_f32 v246, v244, v241, v243
    v_fma_f32 v244, v244, v35, v242
    v_exp_f32 v246, v246
    v_mov_b32 v247, v244
    v_add_f32 v246, 1.0, v246
    v_rcp_f32 v246, v246
    v_permlane32_swap_b32 v244, v247
    v_mul_f32 v246, v246, v244
    v_mul_f32 v246, v246, v247
    v_cvt_pk_bf16_f32 v246, v246, v246
    ds_write_b16 v16, v246
    s_waitcnt lgkmcnt(0)
    s_barrier
    ds_read_b128 v[200:203], v17 offset:0
    ds_read_b128 v[204:207], v17 offset:64
L_t79_far:
    s_waitcnt lgkmcnt(1)
    v_mfma_f32_16x16x32_bf16 v[216:219], v[200:203], v[176:179], 0
    s_waitcnt lgkmcnt(0)
    v_mfma_f32_16x16x32_bf16 v[216:219], v[204:207], v[180:183], v[216:219]
    s_nop 7
    v_and_or_b32 v244, v216, s71, v32
    buffer_store_dword v244, v9, s[44:47], s74 offen offset:0 sc1
    s_add_u32 s74, s74, 131072
    s_add_u32 s66, s52, 20
    s_cmp_lg_u32 s53, s66
    s_cbranch_scc1 L_fin_far
    s_waitcnt vmcnt(0)
    buffer_load_dwordx4 v[184:187], v1, s[44:47], s72 offen offset:0 sc1
    buffer_load_dwordx4 v[188:191], v1, s[44:47], s72 offen offset:1024 sc1
    s_branch L_g82_far
L_r81_far:
    buffer_load_dwordx4 v[184:187], v1, s[44:47], s72 offen offset:0 sc1
    buffer_load_dwordx4 v[188:191], v1, s[44:47], s72 offen offset:1024 sc1
    s_sub_u32 s61, s61, 1
    s_cbranch_scc1 L_end
L_g82_far:
    s_waitcnt vmcnt(1)
    v_xor_b32 v184, s55, v184
    v_xor_b32 v185, s56, v185
    v_xor_b32 v186, s57, v186
    v_xor_b32 v187, s58, v187
    v_or3_b32 v238, v184, v185, v186
    s_waitcnt vmcnt(0)
    v_xor_b32 v188, s55, v188
    v_xor_b32 v190, s57, v190
    v_add_f32 v244, v184, v188
    v_add_f32 v246, v186, v190
    v_xor_b32 v189, s56, v189
    v_xor_b32 v191, s58, v191
    v_permlane32_swap_b32 v244, v246
    v_add_f32 v245, v185, v189
    v_add_f32 v247, v187, v191
    v_add_f32 v244, v244, v246
    v_or3_b32 v238, v238, v187, v188
    v_permlane32_swap_b32 v245, v247
    v_add_f32 v245, v245, v247
    v_or3_b32 v238, v238, v189, v190
    v_or_b32 v238, v238, v191
    v_permlane16_swap_b32 v244, v245
    v_add_f32 v244, v244, v245
    v_and_b32 v238, 0xff, v238
    v_cmp_ne_u32 vcc, 0, v238
    v_add_f32_dpp v244, v244, v244 row_ror:8
    s_cbranch_vccnz L_r81_far
    s_nop 0
    v_add_f32_dpp v244, v244, v244 row_ror:4
    v_cvt_pk_bf16_f32 v244, v244, v244
    v_and_b32 v244, s69, v244
    v_add_f32 v244, v244, v33
    v_cvt_pk_bf16_f32 v237, v244, v244
    s_add_u32 s72, s72, 131072
    buffer_store_short v237, v13, s[40:43], 0 offen
L_fin_far:
    s_endpgm
L_tag_far:
    s_cmp_lg_u32 s49, 0
    s_cbranch_scc1 L_fin_far
    v_cmp_eq_u32 vcc, 0, v0
    v_mov_b32 v238, 1073741824
    v_mov_b32 v239, s54
    v_cndmask_b32_e64 v238, v238, 0, vcc
    buffer_store_dword v239, v238, s[44:47], 0 offen sc1
    s_branch L_fin_far
L_g014_far:
    buffer_store_dword v32, v9, s[44:47], s74 offen offset:0 sc1
    v_cmp_gt_u32 vcc, 8, v4
    v_mov_b32 v50, 1073741824
    v_not_b32 v224, s55
    v_not_b32 v225, s56
    v_not_b32 v226, s57
    v_not_b32 v227, s58
    v_cndmask_b32 v50, v50, v49, vcc
    s_add_u32 s67, s74, 131072
    buffer_store_dwordx4 v[224:227], v50, s[44:47], s67 offen sc1
    s_lshl_b32 s66, s53, 6
    s_add_u32 s66, s66, s74
    s_add_u32 s66, s66, 0
    s_add_u32 s67, s66, 8192
    s_load_dword s28, s[44:45], s66 glc
    s_load_dword s29, s[44:45], s67 glc
    s_waitcnt lgkmcnt(0)
    s_memtime s[80:81]
    s_load_dword s28, s[44:45], s66 glc
    s_waitcnt lgkmcnt(0)
    s_mov_b32 s66, s80
    s_memtime s[80:81]
    s_load_dword s28, s[44:45], s67 glc
    s_waitcnt lgkmcnt(0)
    s_mov_b32 s67, s80
    s_memtime s[80:81]
    s_sub_u32 s66, s67, s66
    s_waitcnt lgkmcnt(0)
    s_sub_u32 s67, s80, s67
    s_cmp_gt_u32 s66, s67
    s_cselect_b32 s3, 1, 0
    s_cselect_b32 s72, 8192, 0
    s_add_u32 s72, s72, s74
    s_sub_u32 s72, s72, 131072
    s_add_u32 s74, s74, 131072
    s_waitcnt vmcnt(0)
    buffer_load_dwordx4 v[184:187], v1, s[44:47], s72 offen offset:0 sc1
    buffer_load_dwordx4 v[188:191], v1, s[44:47], s72 offen offset:1024 sc1
    s_branch L_g84_far
L_r83_far:
    buffer_load_dwordx4 v[184:187], v1, s[44:47], s72 offen offset:0 sc1
    buffer_load_dwordx4 v[188:191], v1, s[44:47], s72 offen offset:1024 sc1
    s_sub_u32 s61, s61, 1
    s_cbranch_scc1 L_end
L_g84_far:
    s_waitcnt vmcnt(1)
    v_xor_b32 v184, s55, v184
    v_xor_b32 v185, s56, v185
    v_xor_b32 v186, s57, v186
    v_xor_b32 v187, s58, v187
    v_or3_b32 v238, v184, v185, v186
    s_waitcnt vmcnt(0)
    v_xor_b32 v188, s55, v188
    v_xor_b32 v190, s57, v190
    v_add_f32 v244, v184, v188
    v_add_f32 v246, v186, v190
    v_xor_b32 v189, s56, v189
    v_xor_b32 v191, s58, v191
    v_permlane32_swap_b32 v244, v246
    v_add_f32 v245, v185, v189
    v_add_f32 v247, v187, v191
    v_add_f32 v244, v244, v246
    v_or3_b32 v238, v238, v187, v188
    v_permlane32_swap_b32 v245, v247
    v_add_f32 v245, v245, v247
    v_or3_b32 v238, v238, v189, v190
    v_or_b32 v238, v238, v191
    v_permlane16_swap_b32 v244, v245
    v_add_f32 v244, v244, v245
    v_and_b32 v238, 0xff, v238
    v_cmp_ne_u32 vcc, 0, v238
    v_add_f32_dpp v244, v244, v244 row_ror:8
    s_cbranch_vccnz L_r83_far
    s_nop 0
    v_add_f32_dpp v244, v244, v244 row_ror:4
    v_cvt_pk_bf16_f32 v244, v244, v244
    v_and_b32 v244, s69, v244
    v_add_f32 v244, v244, v33
    v_cvt_pk_bf16_f32 v237, v244, v244
    s_add_u32 s72, s72, 131072
    v_and_b32 v33, s69, v237
    v_mov_b32 v239, s3
    buffer_store_dword v239, v11, s[44:47], s63 offen offset:0 sc1
L_s85_far:
    buffer_load_dword v236, v12, s[44:47], s63 offen offset:0 sc1
    s_sub_u32 s61, s61, 1
    s_cbranch_scc1 L_end
    s_waitcnt vmcnt(0)
    v_cmp_eq_u32 vcc, -1, v236
    s_cbranch_vccnz L_s85_far
    v_and_b32 v242, 1, v236
    v_cmp_ne_u32 vcc, 0, v242
    s_nop 0
    s_bcnt1_i32_b64 s66, vcc
    s_cmp_ge_u32 s66, 46
    s_cselect_b32 s72, 8192, 0
    s_add_u32 s72, s72, s74
    s_sub_u32 s72, s72, 131072
    s_add_u32 s67, s74, 131072
    buffer_store_dword v32, v9, s[44:47], s67 offen offset:0 sc1
    s_branch L_join15_far
L_u13_far:
    s_waitcnt lgkmcnt(0)
    ds_read_b32 v251, v22 offset:2944
    ds_read_b128 v[200:203], v19 offset:0
    ds_read_b128 v[204:207], v19 offset:64
    ds_read_b128 v[208:211], v19 offset:128
    ds_read_b128 v[212:215], v19 offset:192
    s_sub_u32 s61, s61, 1
    s_cbranch_scc1 L_end
    s_branch L_t12_far
L_u49_far:
    s_waitcnt lgkmcnt(0)
    ds_read_b32 v251, v22 offset:3200
    ds_read_b128 v[200:203], v19 offset:0
    ds_read_b128 v[204:207], v19 offset:64
    ds_read_b128 v[208:211], v19 offset:128
    ds_read_b128 v[212:215], v19 offset:192
    s_sub_u32 s61, s61, 1
    s_cbranch_scc1 L_end
    s_branch L_t48_far
L_u51_far:
    s_waitcnt lgkmcnt(0)
    ds_read_b32 v239, v22 offset:3264
    ds_read_b128 v[200:203], v24
    ds_read_b128 v[232:235], v28
    ds_read_b128 v[204:207], v25
    ds_read_b128 v[208:211], v26
    ds_read_b128 v[212:215], v27
    s_sub_u32 s61, s61, 1
    s_cbranch_scc1 L_end
    s_branch L_t50_far
L_u64_far:
    s_waitcnt lgkmcnt(0)
    ds_read_b32 v251, v22 offset:3328
    ds_read_b128 v[200:203], v19 offset:0
    ds_read_b128 v[204:207], v19 offset:64
    ds_read_b128 v[208:211], v19 offset:128
    ds_read_b128 v[212:215], v19 offset:192
    s_sub_u32 s61, s61, 1
    s_cbranch_scc1 L_end
    s_branch L_t63_far
L_fin:
L_end:
    s_endpgm
.section .rodata,"a"
.p2align 6
.amdhsa_kernel interleave_layers__sliding_block_cached__glu_gated_swiglu__decode_kernel
  .amdhsa_next_free_vgpr 256
  .amdhsa_next_free_sgpr 102
  .amdhsa_accum_offset 256
  .amdhsa_group_segment_fixed_size 0
  .amdhsa_kernarg_size 96
  .amdhsa_user_sgpr_count 2
  .amdhsa_user_sgpr_kernarg_segment_ptr 1
  .amdhsa_system_sgpr_workgroup_id_x 1
.end_amdhsa_kernel
```
